```python
import torch

def _softmax(x, axis=-1):
    return torch.softmax(x, dim=axis)
def _gelu(x):
    return torch.nn.functional.gelu(x, approximate="tanh")
def _silu(x):
    return torch.nn.functional.silu(x)
def _sigmoid(x):
    return torch.sigmoid(x)
def _layernorm(x, axis=-1, eps=1e-5):
    m = x.mean(dim=axis, keepdim=True)
    v = x.var(dim=axis, keepdim=True, unbiased=False)
    return (x - m) / torch.sqrt(v + eps)
def _scatter_add(tgt, idx, src, axis=0):
    return tgt.clone().index_add_(axis, idx, src)
def _segment_sum(src, seg, n):
    out = torch.zeros((n,) + src.shape[1:], dtype=src.dtype)
    return out.index_add_(0, seg, src)
def _pad(x, pw):
    flat = tuple(v for pair in reversed(pw) for v in pair)
    return torch.nn.functional.pad(x, flat)

kernel_name = 'standalone__gqa_softmax__near_ridge'

def setup_inputs():

    _w = (lambda a: (lambda t: t.to(torch.bfloat16) if t.is_floating_point() else t)(torch.as_tensor(a)))
    B, Hq, Hkv, Sq, Sk, D = 8, 32, 8, 112, 1024, 128
    return {
        "q": _w((lambda *s: torch.randn(*s, dtype=torch.bfloat16) * 0.8)(B, Hq, Sq, D)),
        "k": _w((lambda *s: torch.randn(*s, dtype=torch.bfloat16) * 0.8)(B, Hkv, Sk, D)),
        "v": _w((lambda *s: torch.randn(*s, dtype=torch.bfloat16) * 0.05)(B, Hkv, Sk, D)),
    }

def reference(q, k, v):
    B, Hq, Sq, D = q.shape
    Hkv = k.shape[1]
    rep = Hq // Hkv
    k = (lambda x, n, axis: torch.repeat_interleave(x, n, dim=axis))(k, rep, axis=1)
    v = (lambda x, n, axis: torch.repeat_interleave(x, n, dim=axis))(v, rep, axis=1)
    scale = D ** -0.5
    scores = torch.einsum("bhqd,bhkd->bhqk", q, k) * scale
    p = _softmax(scores, axis=-1)
    return torch.einsum("bhqk,bhkd->bhqd", p, v)
```

```asm
; @launch grid=(256,1,1) block=(256,1,1) lds=163840
.amdgcn_target "amdgcn-amd-amdhsa--gfx950"
.text
.globl standalone__gqa_softmax__near_ridge_kernel
.p2align 12
.fill 768, 4, 0xbf810000
.p2align 8
.type standalone__gqa_softmax__near_ridge_kernel,@function
standalone__gqa_softmax__near_ridge_kernel:
    s_load_dwordx8 s[4:11], s[0:1], 0
    s_cmp_ge_u32 s2, 256
    s_cbranch_scc1 L_end
    v_lshrrev_b32 v20, 6, v0
    v_and_b32 v0, 63, v0
    v_readfirstlane_b32 s3, v20
    s_and_b32 s36, s2, 7
    s_lshr_b32 s37, s2, 3
    s_lshl_b32 s36, s36, 5
    s_add_u32 s36, s36, s37
    s_mul_i32 s38, s36, 28672
    s_mul_i32 s34, s3, 40960
    s_movk_i32 s14, 28672
    s_mov_b32 s15, 0x20000
    s_lshl_b32 s40, s3, 12
    s_mov_b32 s33, 0
    s_mov_b64 s[88:89], 0
L_start:
    v_lshrrev_b32 v20, 3, v0
    v_and_b32 v21, 6, v20
    v_xor_b32 v21, v21, v0
    v_and_b32 v21, 7, v21
    v_lshlrev_b32 v21, 4, v21
    v_lshl_add_u32 v4, v20, 8, v21
    v_xor_b32 v5, 16, v4
    v_add_u32 v5, 0x400, v5
    s_add_u32 m0, s34, 32768
    s_add_u32 s41, s40, 128
    s_lshr_b32 s39, s36, 2
    s_lshl_b32 s39, s39, 18
    s_lshl_b32 s42, s3, 16
    s_add_u32 s39, s39, s42
    s_mov_b32 s18, 0x10000
    s_mov_b32 s19, 0x20000
    s_mov_b32 s32, 0
    s_movk_i32 s43, 128
    s_getpc_b64 s[94:95]
L_pc:
    s_lshl_b32 s97, s3, 5
    s_add_u32 s97, s97, s37
    s_lshl_b32 s97, s97, 6
    s_add_u32 s96, s97, 1024-(L_pc-standalone__gqa_softmax__near_ridge_kernel)
    s_add_u32 s96, s94, s96
    v_mov_b32 v22, s96
    s_addc_u32 s96, s95, 0
    v_mov_b32 v23, s96
    global_load_dword v40, v[22:23], off
    s_waitcnt lgkmcnt(0)
    s_add_u32 s12, s4, s38
    s_addc_u32 s13, s5, 0
    buffer_load_dwordx4 v4, s[12:15], s40 offen offset:0 lds
    buffer_load_dwordx4 v5, s[12:15], s40 offen offset:1024 lds
    s_add_u32 m0, s34, 36864
    s_add_u32 s16, s6, s39
    s_addc_u32 s17, s7, 0
    buffer_load_dwordx4 v4, s[12:15], s41 offen offset:0 lds
    buffer_load_dwordx4 v5, s[12:15], s41 offen offset:1024 lds
    s_add_u32 m0, s34, 0
    s_cmp_eq_u32 s3, 3
    buffer_load_dwordx4 v4, s[16:19], s32 offen offset:0 lds
    buffer_load_dwordx4 v5, s[16:19], s32 offen offset:1024 lds
    s_cselect_b32 s45, 0x4000, 0
    s_add_u32 m0, s34, 4096
    s_add_u32 s45, s45, s34
    buffer_load_dwordx4 v4, s[16:19], s43 offen offset:0 lds
    buffer_load_dwordx4 v5, s[16:19], s43 offen offset:1024 lds
    v_add_u32 v6, 0x800, v4
    v_add_u32 v7, 0x800, v5
    s_add_u32 m0, s45, 36864
    s_add_u32 s42, s41, 0x3000
    buffer_load_dwordx4 v6, s[12:15], s42 offen offset:2048 lds
    buffer_load_dwordx4 v7, s[12:15], s42 offen offset:3072 lds
    s_add_u32 m0, s45, 32768
    s_add_u32 s42, s40, 0x3000
    buffer_load_dwordx4 v6, s[12:15], s42 offen offset:2048 lds
    buffer_load_dwordx4 v7, s[12:15], s42 offen offset:3072 lds
    s_add_u32 s20, s8, s39
    s_addc_u32 s21, s9, 0
    s_add_u32 s24, s10, s38
    s_addc_u32 s25, s11, 0
    s_mov_b32 s22, 0x10000
    s_mov_b32 s23, 0x20000
    s_movk_i32 s26, 28672
    s_mov_b32 s27, 0x20000
    s_lshr_b32 s30, s3, 1
    s_lshl_b32 s30, s30, 7
    s_xor_b32 s31, s30, 128
    v_and_b32 v20, 15, v0
    v_and_b32 v21, 6, v20
    v_lshrrev_b32 v22, 3, v20
    v_or_b32 v21, v21, v22
    v_lshrrev_b32 v22, 4, v0
    v_lshlrev_b32 v22, 1, v22
    v_xor_b32 v21, v21, v22
    v_lshlrev_b32 v21, 4, v21
    v_lshl_add_u32 v21, v20, 7, v21
    v_add_u32 v8, s34, v21
    v_xor_b32 v9, 16, v8
    v_lshl_add_u32 v1, v0, 4, s34
    v_mov_b32 v58, 0x3e0293ee
    v_lshl_add_u32 v57, v0, 4, s45
    s_lshl_b32 s42, s3, 8
    v_lshlrev_b32 v23, 4, v20
    v_add_u32 v19, 161792, v23
    v_add_u32 v56, s42, v19
    v_lshlrev_b32 v23, 4, v0
    v_add_u32 v14, 32768, v23
    v_add_u32 v15, 114688, v23
    s_xor_b32 s42, s3, 1
    s_mul_i32 s90, s42, 40960
    s_xor_b32 s42, s3, 2
    s_mul_i32 s91, s42, 40960
    s_xor_b32 s42, s3, 3
    s_mul_i32 s92, s42, 40960
    s_lshl_b32 s93, s3, 2
    s_sub_u32 s93, s93, 4096
    v_lshrrev_b32 v21, 4, v0
    v_lshrrev_b32 v22, 2, v20
    v_cmp_eq_u32 vcc, v21, v22
    v_and_b32 v22, 1, v0
    v_lshlrev_b32 v22, 4, v22
    v_mov_b32 v23, 0x3f80
    v_lshlrev_b32 v23, v22, v23
    v_cndmask_b32 v23, 0, v23, vcc
    v_and_b32 v22, 2, v0
    v_cmp_eq_u32 vcc, 0, v22
    v_bfe_u32 v24, v0, 4, 1
    v_lshrrev_b32 v25, 5, v0
    v_cndmask_b32 v16, 0, v23, vcc
    v_sub_u32 v17, v23, v16
    v_accvgpr_write_b32 a128, 0
    v_accvgpr_write_b32 a129, 0
    v_accvgpr_write_b32 a130, v16
    v_accvgpr_write_b32 a131, v17
    v_accvgpr_write_b32 a132, 0
    v_accvgpr_write_b32 a133, 0
    v_lshl_add_u32 v24, v24, 1, v25
    v_lshlrev_b32 v24, 4, v24
    v_lshl_add_u32 v24, v20, 8, v24
    s_lshl_b32 s42, s3, 6
    v_add_u32 v18, s42, v24
    v_and_b32 v22, 3, v0
    v_cmp_eq_u32 vcc, 0, v22
    v_lshrrev_b32 v20, 2, v0
    v_and_b32 v21, 6, v20
    v_lshrrev_b32 v22, 3, v20
    v_or_b32 v21, v21, v22
    v_bfe_u32 v22, v0, 1, 1
    v_xor_b32 v21, v21, v22
    s_and_b32 s42, s3, 1
    s_lshl_b32 s42, s42, 2
    v_xor_b32 v21, s42, v21
    v_lshlrev_b32 v21, 4, v21
    v_lshl_add_u32 v21, v20, 7, v21
    v_and_b32 v22, 1, v0
    v_lshl_add_u32 v21, v22, 3, v21
    v_add_u32 v10, s34, v21
    v_xor_b32 v11, 32, v10
    v_xor_b32 v12, 64, v10
    v_xor_b32 v13, 96, v10
    v_mov_b32 v22, 0x3f803f80
    v_cndmask_b32 v22, 0, v22, vcc
    v_accvgpr_write_b32 a56, v22
    v_accvgpr_write_b32 a57, v22
    v_accvgpr_write_b32 a58, v22
    v_accvgpr_write_b32 a59, v22
    s_and_b32 s97, s97, 0xfff
    s_add_u32 s97, s97, 9216-(L_pc-standalone__gqa_softmax__near_ridge_kernel)
    s_add_u32 s94, s94, s97
    s_addc_u32 s95, s95, 0
    v_mov_b32 v16, s94
    v_mov_b32 v17, s95
    v_add_u32 v20, s93, v19
    v_mov_b32 v21, 0xf1800000
    ds_write_b32 v20, v21 offset:0
    ds_write_b32 v20, v21 offset:256
    ds_write_b32 v20, v21 offset:512
    ds_write_b32 v20, v21 offset:768
    ds_write_b32 v20, v21 offset:1024
    ds_write_b32 v20, v21 offset:1280
    ds_write_b32 v20, v21 offset:1536
    s_add_u32 m0, s34, 4096
    s_nop 0
    buffer_load_dwordx4 v6, s[16:19], s43 offen offset:2048 lds
    buffer_load_dwordx4 v7, s[16:19], s43 offen offset:3072 lds
    s_add_u32 m0, s34, 0
    s_nop 0
    buffer_load_dwordx4 v6, s[16:19], s32 offen offset:2048 lds
    buffer_load_dwordx4 v7, s[16:19], s32 offen offset:3072 lds
    s_waitcnt vmcnt(12)
    ds_read_b128 v[116:119], v8 offset:32768
    ds_read_b128 v[120:123], v9 offset:32768
    ds_read_b128 v[124:127], v8 offset:36864
    ds_read_b128 v[128:131], v9 offset:36864
    s_waitcnt vmcnt(8)
    ds_read_b128 a[60:63], v8 offset:0
    ds_read_b128 a[64:67], v9 offset:0
    ds_read_b128 a[68:71], v8 offset:4096
    ds_read_b128 a[72:75], v9 offset:4096
    s_add_u32 m0, s34, 16384
    s_nop 0
    buffer_load_dwordx4 v4, s[20:23], s30 offen offset:0 lds
    buffer_load_dwordx4 v5, s[20:23], s30 offen offset:1024 lds
    s_waitcnt lgkmcnt(7)
    v_lshlrev_b32 v148, 16, v116
    v_and_b32 v149, 0xffff0000, v116
    v_lshlrev_b32 v150, 16, v117
    v_and_b32 v151, 0xffff0000, v117
    v_lshlrev_b32 v152, 16, v118
    v_and_b32 v153, 0xffff0000, v118
    v_lshlrev_b32 v154, 16, v119
    v_and_b32 v155, 0xffff0000, v119
    v_pk_mul_f32 v[148:149], v[148:149], v[58:59] op_sel_hi:[1,0]
    v_pk_mul_f32 v[150:151], v[150:151], v[58:59] op_sel_hi:[1,0]
    v_pk_mul_f32 v[152:153], v[152:153], v[58:59] op_sel_hi:[1,0]
    v_pk_mul_f32 v[154:155], v[154:155], v[58:59] op_sel_hi:[1,0]
    v_cvt_pk_bf16_f32 v60, v148, v149
    v_cvt_pk_bf16_f32 v61, v150, v151
    v_cvt_pk_bf16_f32 v62, v152, v153
    v_cvt_pk_bf16_f32 v63, v154, v155
    s_waitcnt lgkmcnt(0)
    v_mfma_f32_16x16x32_bf16 v[20:23], a[60:63], v[116:119], 0
    ds_write_b128 v1, v[60:63] offset:32768
    v_mfma_f32_16x16x32_bf16 v[20:23], a[64:67], v[120:123], v[20:23]
    v_lshlrev_b32 v148, 16, v120
    v_and_b32 v149, 0xffff0000, v120
    v_mfma_f32_16x16x32_bf16 v[20:23], a[68:71], v[124:127], v[20:23]
    v_lshlrev_b32 v150, 16, v121
    v_and_b32 v151, 0xffff0000, v121
    v_mfma_f32_16x16x32_bf16 v[20:23], a[72:75], v[128:131], v[20:23]
    v_lshlrev_b32 v152, 16, v122
    v_and_b32 v153, 0xffff0000, v122
    v_lshlrev_b32 v154, 16, v123
    v_and_b32 v155, 0xffff0000, v123
    v_pk_mul_f32 v[148:149], v[148:149], v[58:59] op_sel_hi:[1,0]
    v_pk_mul_f32 v[150:151], v[150:151], v[58:59] op_sel_hi:[1,0]
    v_pk_mul_f32 v[152:153], v[152:153], v[58:59] op_sel_hi:[1,0]
    v_pk_mul_f32 v[154:155], v[154:155], v[58:59] op_sel_hi:[1,0]
    v_cvt_pk_bf16_f32 v64, v148, v149
    v_cvt_pk_bf16_f32 v65, v150, v151
    v_cvt_pk_bf16_f32 v66, v152, v153
    v_cvt_pk_bf16_f32 v67, v154, v155
    ds_write_b128 v1, v[64:67] offset:33792
    buffer_load_dwordx4 v6, s[20:23], s30 offen offset:2048 lds
    buffer_load_dwordx4 v7, s[20:23], s30 offen offset:3072 lds
    v_lshlrev_b32 v148, 16, v124
    v_and_b32 v149, 0xffff0000, v124
    v_max3_f32 v28, v20, v21, v22
    v_lshlrev_b32 v150, 16, v125
    v_and_b32 v151, 0xffff0000, v125
    v_max_f32 v28, v28, v23
    v_lshlrev_b32 v152, 16, v126
    v_and_b32 v153, 0xffff0000, v126
    v_mov_b32 v29, v28
    v_lshlrev_b32 v154, 16, v127
    v_and_b32 v155, 0xffff0000, v127
    v_permlane16_swap_b32 v28, v29
    v_pk_mul_f32 v[148:149], v[148:149], v[58:59] op_sel_hi:[1,0]
    v_pk_mul_f32 v[150:151], v[150:151], v[58:59] op_sel_hi:[1,0]
    v_max_f32 v28, v28, v29
    v_pk_mul_f32 v[152:153], v[152:153], v[58:59] op_sel_hi:[1,0]
    v_pk_mul_f32 v[154:155], v[154:155], v[58:59] op_sel_hi:[1,0]
    v_mov_b32 v29, v28
    v_cvt_pk_bf16_f32 v68, v148, v149
    v_cvt_pk_bf16_f32 v69, v150, v151
    v_permlane32_swap_b32 v28, v29
    v_cvt_pk_bf16_f32 v70, v152, v153
    v_cvt_pk_bf16_f32 v71, v154, v155
    v_max_f32 v28, v28, v29
    ds_write_b128 v1, v[68:71] offset:36864
    v_lshlrev_b32 v148, 16, v128
    v_and_b32 v149, 0xffff0000, v128
    v_mul_f32 v28, v28, v58
    v_lshlrev_b32 v150, 16, v129
    v_and_b32 v151, 0xffff0000, v129
    v_cndmask_b32 v28, v28, v2, s[88:89]
    v_lshlrev_b32 v152, 16, v130
    v_and_b32 v153, 0xffff0000, v130
    v_sub_f32 v20, 0, v28
    v_lshlrev_b32 v154, 16, v131
    v_and_b32 v155, 0xffff0000, v131
    v_sub_f32 v21, 0, v28
    v_pk_mul_f32 v[148:149], v[148:149], v[58:59] op_sel_hi:[1,0]
    v_pk_mul_f32 v[150:151], v[150:151], v[58:59] op_sel_hi:[1,0]
    v_sub_f32 v22, 0, v28
    v_pk_mul_f32 v[152:153], v[152:153], v[58:59] op_sel_hi:[1,0]
    v_pk_mul_f32 v[154:155], v[154:155], v[58:59] op_sel_hi:[1,0]
    v_sub_f32 v23, 0, v28
    v_cvt_pk_bf16_f32 v72, v148, v149
    v_cvt_pk_bf16_f32 v73, v150, v151
    v_cvt_pk_bf16_f32 v74, v152, v153
    v_cvt_pk_bf16_f32 v75, v154, v155
    ds_write_b128 v1, v[72:75] offset:37888
    ds_write_b128 v56, v[20:23] offset:0
    s_add_u32 m0, s34, 20480
    s_nop 0
    buffer_load_dwordx4 v4, s[20:23], s31 offen offset:0 lds
    buffer_load_dwordx4 v5, s[20:23], s31 offen offset:1024 lds
    s_waitcnt lgkmcnt(0)
    s_barrier
    ds_read_b128 v[32:35], v19 offset:0
    ds_read_b128 a[144:147], v14 offset:0
    ds_read_b128 a[148:151], v14 offset:1024
    ds_read_b128 a[152:155], v14 offset:4096
    ds_read_b128 a[156:159], v14 offset:5120
    ds_read_b128 v[36:39], v19 offset:256
    ds_read_b128 a[160:163], v14 offset:40960
    ds_read_b128 a[164:167], v14 offset:41984
    ds_read_b128 a[168:171], v14 offset:45056
    ds_read_b128 a[172:175], v14 offset:46080
    s_waitcnt vmcnt(10)
    ds_read_b128 v[132:135], v8 offset:34816
    ds_read_b128 v[136:139], v9 offset:34816
    ds_read_b128 v[140:143], v8 offset:38912
    ds_read_b128 v[144:147], v9 offset:38912
    buffer_load_dwordx4 v6, s[20:23], s31 offen offset:2048 lds
    buffer_load_dwordx4 v7, s[20:23], s31 offen offset:3072 lds
    s_waitcnt lgkmcnt(3)
    v_lshlrev_b32 v148, 16, v132
    v_and_b32 v149, 0xffff0000, v132
    v_lshlrev_b32 v150, 16, v133
    v_and_b32 v151, 0xffff0000, v133
    v_lshlrev_b32 v152, 16, v134
    v_and_b32 v153, 0xffff0000, v134
    v_lshlrev_b32 v154, 16, v135
    v_and_b32 v155, 0xffff0000, v135
    v_pk_mul_f32 v[148:149], v[148:149], v[58:59] op_sel_hi:[1,0]
    v_pk_mul_f32 v[150:151], v[150:151], v[58:59] op_sel_hi:[1,0]
    v_pk_mul_f32 v[152:153], v[152:153], v[58:59] op_sel_hi:[1,0]
    v_pk_mul_f32 v[154:155], v[154:155], v[58:59] op_sel_hi:[1,0]
    v_cvt_pk_bf16_f32 v76, v148, v149
    v_cvt_pk_bf16_f32 v77, v150, v151
    v_cvt_pk_bf16_f32 v78, v152, v153
    v_cvt_pk_bf16_f32 v79, v154, v155
    s_waitcnt lgkmcnt(0)
    v_mfma_f32_16x16x32_bf16 v[24:27], a[60:63], v[132:135], 0
    ds_write_b128 v57, v[76:79] offset:34816
    v_mfma_f32_16x16x32_bf16 v[24:27], a[64:67], v[136:139], v[24:27]
    v_lshlrev_b32 v148, 16, v136
    v_and_b32 v149, 0xffff0000, v136
    v_mfma_f32_16x16x32_bf16 v[24:27], a[68:71], v[140:143], v[24:27]
    v_lshlrev_b32 v150, 16, v137
    v_and_b32 v151, 0xffff0000, v137
    v_mfma_f32_16x16x32_bf16 v[24:27], a[72:75], v[144:147], v[24:27]
    v_lshlrev_b32 v152, 16, v138
    v_and_b32 v153, 0xffff0000, v138
    v_lshlrev_b32 v154, 16, v139
    v_and_b32 v155, 0xffff0000, v139
    v_pk_mul_f32 v[148:149], v[148:149], v[58:59] op_sel_hi:[1,0]
    v_pk_mul_f32 v[150:151], v[150:151], v[58:59] op_sel_hi:[1,0]
    v_pk_mul_f32 v[152:153], v[152:153], v[58:59] op_sel_hi:[1,0]
    v_pk_mul_f32 v[154:155], v[154:155], v[58:59] op_sel_hi:[1,0]
    v_cvt_pk_bf16_f32 v80, v148, v149
    v_cvt_pk_bf16_f32 v81, v150, v151
    v_cvt_pk_bf16_f32 v82, v152, v153
    v_cvt_pk_bf16_f32 v83, v154, v155
    ds_write_b128 v57, v[80:83] offset:35840
    v_lshlrev_b32 v148, 16, v140
    v_and_b32 v149, 0xffff0000, v140
    v_max3_f32 v30, v24, v25, v26
    v_lshlrev_b32 v150, 16, v141
    v_and_b32 v151, 0xffff0000, v141
    v_max_f32 v30, v30, v27
    v_lshlrev_b32 v152, 16, v142
    v_and_b32 v153, 0xffff0000, v142
    v_mov_b32 v31, v30
    v_lshlrev_b32 v154, 16, v143
    v_and_b32 v155, 0xffff0000, v143
    v_permlane16_swap_b32 v30, v31
    v_pk_mul_f32 v[148:149], v[148:149], v[58:59] op_sel_hi:[1,0]
    v_pk_mul_f32 v[150:151], v[150:151], v[58:59] op_sel_hi:[1,0]
    v_max_f32 v30, v30, v31
    v_pk_mul_f32 v[152:153], v[152:153], v[58:59] op_sel_hi:[1,0]
    v_pk_mul_f32 v[154:155], v[154:155], v[58:59] op_sel_hi:[1,0]
    v_mov_b32 v31, v30
    v_cvt_pk_bf16_f32 v84, v148, v149
    v_cvt_pk_bf16_f32 v85, v150, v151
    v_permlane32_swap_b32 v30, v31
    v_cvt_pk_bf16_f32 v86, v152, v153
    v_cvt_pk_bf16_f32 v87, v154, v155
    v_max_f32 v30, v30, v31
    ds_write_b128 v57, v[84:87] offset:38912
    v_lshlrev_b32 v148, 16, v144
    v_and_b32 v149, 0xffff0000, v144
    v_mul_f32 v30, v30, v58
    v_lshlrev_b32 v150, 16, v145
    v_and_b32 v151, 0xffff0000, v145
    v_cndmask_b32 v30, v30, v3, s[88:89]
    v_lshlrev_b32 v152, 16, v146
    v_and_b32 v153, 0xffff0000, v146
    v_sub_f32 v24, 0, v30
    v_lshlrev_b32 v154, 16, v147
    v_and_b32 v155, 0xffff0000, v147
    v_sub_f32 v25, 0, v30
    v_pk_mul_f32 v[148:149], v[148:149], v[58:59] op_sel_hi:[1,0]
    v_pk_mul_f32 v[150:151], v[150:151], v[58:59] op_sel_hi:[1,0]
    v_sub_f32 v26, 0, v30
    v_pk_mul_f32 v[152:153], v[152:153], v[58:59] op_sel_hi:[1,0]
    v_pk_mul_f32 v[154:155], v[154:155], v[58:59] op_sel_hi:[1,0]
    v_sub_f32 v27, 0, v30
    v_cvt_pk_bf16_f32 v88, v148, v149
    v_cvt_pk_bf16_f32 v89, v150, v151
    v_cvt_pk_bf16_f32 v90, v152, v153
    v_cvt_pk_bf16_f32 v91, v154, v155
    ds_write_b128 v57, v[88:91] offset:39936
    ds_write_b128 v56, v[24:27] offset:1024
    s_add_u32 s32, s32, 0x2000
    s_add_u32 m0, s34, 8192
    s_or_b32 s44, s32, 0
    buffer_load_dwordx4 v4, s[16:19], s44 offen offset:0 lds
    buffer_load_dwordx4 v5, s[16:19], s44 offen offset:1024 lds
    s_waitcnt vmcnt(10)
    ds_read_b128 a[76:79], v8 offset:2048
    ds_read_b128 a[80:83], v9 offset:2048
    ds_read_b128 a[84:87], v8 offset:6144
    ds_read_b128 a[88:91], v9 offset:6144
    s_cmp_eq_u32 s33, 1
    s_cbranch_scc1 L_pass1
    v_mfma_f32_16x16x32_bf16 v[20:23], a[60:63], a[144:147], v[32:35]
    buffer_load_dwordx4 v6, s[16:19], s44 offen offset:2048 lds
    v_mfma_f32_16x16x32_bf16 v[20:23], a[64:67], a[148:151], v[20:23]
    buffer_load_dwordx4 v7, s[16:19], s44 offen offset:3072 lds
    v_mfma_f32_16x16x32_bf16 v[20:23], a[68:71], a[152:155], v[20:23]
    s_add_u32 m0, s34, 12288
    s_or_b32 s44, s32, 128
    buffer_load_dwordx4 v4, s[16:19], s44 offen offset:0 lds
    v_mfma_f32_16x16x32_bf16 v[20:23], a[72:75], a[156:159], v[20:23]
    s_waitcnt vmcnt(9) lgkmcnt(0)
    v_mfma_f32_16x16x32_bf16 v[24:27], a[76:79], a[144:147], v[32:35]
    ds_read_b64_tr_b16 a[92:93], v10 offset:16384
    ds_read_b64_tr_b16 a[94:95], v10 offset:18432
    v_mfma_f32_16x16x32_bf16 v[24:27], a[80:83], a[148:151], v[24:27]
    ds_read_b64_tr_b16 a[96:97], v11 offset:16384
    ds_read_b64_tr_b16 a[98:99], v11 offset:18432
    v_mfma_f32_16x16x32_bf16 v[24:27], a[84:87], a[152:155], v[24:27]
    ds_read_b64_tr_b16 a[100:101], v12 offset:16384
    ds_read_b64_tr_b16 a[102:103], v12 offset:18432
    v_mfma_f32_16x16x32_bf16 v[24:27], a[88:91], a[156:159], v[24:27]
    ds_read_b64_tr_b16 a[104:105], v13 offset:16384
    ds_read_b64_tr_b16 a[106:107], v13 offset:18432
    buffer_load_dwordx4 v5, s[16:19], s44 offen offset:1024 lds
    buffer_load_dwordx4 v6, s[16:19], s44 offen offset:2048 lds
    buffer_load_dwordx4 v7, s[16:19], s44 offen offset:3072 lds
    v_exp_f32 v20, v20
    v_exp_f32 v21, v21
    v_exp_f32 v22, v22
    v_exp_f32 v23, v23
    v_cvt_pk_bf16_f32 v28, v20, v21
    v_cvt_pk_bf16_f32 v29, v22, v23
    v_exp_f32 v24, v24
    v_mfma_f32_16x16x32_bf16 v[20:23], a[60:63], a[160:163], v[36:39]
    s_add_u32 m0, s34, 24576
    v_exp_f32 v25, v25
    v_mfma_f32_16x16x32_bf16 v[20:23], a[64:67], a[164:167], v[20:23]
    s_or_b32 s44, s32, s30
    buffer_load_dwordx4 v4, s[20:23], s44 offen offset:0 lds
    v_exp_f32 v26, v26
    v_mfma_f32_16x16x32_bf16 v[20:23], a[68:71], a[168:171], v[20:23]
    v_exp_f32 v27, v27
    v_mfma_f32_16x16x32_bf16 v[20:23], a[72:75], a[172:175], v[20:23]
    s_waitcnt vmcnt(9)
    v_cvt_pk_bf16_f32 v30, v24, v25
    v_cvt_pk_bf16_f32 v31, v26, v27
    v_mfma_f32_16x16x32_bf16 v[24:27], a[76:79], a[160:163], v[36:39]
    ds_read_b64_tr_b16 a[108:109], v10 offset:20480
    ds_read_b64_tr_b16 a[110:111], v10 offset:22528
    v_mfma_f32_16x16x32_bf16 v[24:27], a[80:83], a[164:167], v[24:27]
    ds_read_b64_tr_b16 a[112:113], v11 offset:20480
    ds_read_b64_tr_b16 a[114:115], v11 offset:22528
    v_mfma_f32_16x16x32_bf16 v[24:27], a[84:87], a[168:171], v[24:27]
    ds_read_b64_tr_b16 a[116:117], v12 offset:20480
    ds_read_b64_tr_b16 a[118:119], v12 offset:22528
    v_mfma_f32_16x16x32_bf16 v[24:27], a[88:91], a[172:175], v[24:27]
    ds_read_b64_tr_b16 a[120:121], v13 offset:20480
    ds_read_b64_tr_b16 a[122:123], v13 offset:22528
    s_waitcnt lgkmcnt(8)
    v_mfma_f32_16x16x32_bf16 v[60:63], a[92:95], v[28:31], 0
    ds_read_b128 v[40:43], v19 offset:512
    ds_read_b128 a[176:179], v15 offset:0
    v_mfma_f32_16x16x32_bf16 v[64:67], a[96:99], v[28:31], 0
    ds_read_b128 a[180:183], v15 offset:1024
    ds_read_b128 a[184:187], v15 offset:4096
    v_mfma_f32_16x16x32_bf16 v[116:119], a[100:103], v[28:31], 0
    ds_read_b128 a[188:191], v15 offset:5120
    v_mfma_f32_16x16x32_bf16 v[120:123], a[104:107], v[28:31], 0
    s_waitcnt lgkmcnt(9)
    v_exp_f32 v20, v20
    v_mfma_f32_16x16x32_bf16 v[124:127], a[108:111], v[28:31], 0
    v_exp_f32 v21, v21
    v_mfma_f32_16x16x32_bf16 v[128:131], a[112:115], v[28:31], 0
    s_waitcnt lgkmcnt(5)
    v_exp_f32 v22, v22
    v_mfma_f32_16x16x32_bf16 v[132:135], a[116:119], v[28:31], 0
    buffer_load_dwordx4 v5, s[20:23], s44 offen offset:1024 lds
    v_exp_f32 v23, v23
    v_mfma_f32_16x16x32_bf16 a[0:3], a[120:123], v[28:31], 0
    v_exp_f32 v24, v24
    v_mfma_f32_16x16x32_bf16 a[28:31], a[56:59], v[28:31], 0
    s_waitcnt lgkmcnt(0)
    v_cvt_pk_bf16_f32 v28, v20, v21
    v_cvt_pk_bf16_f32 v29, v22, v23
    v_mfma_f32_16x16x32_bf16 v[20:23], a[60:63], a[176:179], v[40:43]
    v_exp_f32 v25, v25
    v_mfma_f32_16x16x32_bf16 v[20:23], a[64:67], a[180:183], v[20:23]
    v_exp_f32 v26, v26
    v_mfma_f32_16x16x32_bf16 v[20:23], a[68:71], a[184:187], v[20:23]
    v_exp_f32 v27, v27
    v_mfma_f32_16x16x32_bf16 v[20:23], a[72:75], a[188:191], v[20:23]
    v_cvt_pk_bf16_f32 v30, v24, v25
    v_cvt_pk_bf16_f32 v31, v26, v27
    v_mfma_f32_16x16x32_bf16 v[24:27], a[76:79], a[176:179], v[40:43]
    buffer_load_dwordx4 v6, s[20:23], s44 offen offset:2048 lds
    v_mfma_f32_16x16x32_bf16 v[24:27], a[80:83], a[180:183], v[24:27]
    ds_read_b128 v[44:47], v19 offset:768
    ds_read_b128 a[192:195], v15 offset:40960
    v_mfma_f32_16x16x32_bf16 v[24:27], a[84:87], a[184:187], v[24:27]
    ds_read_b128 a[196:199], v15 offset:41984
    v_mfma_f32_16x16x32_bf16 v[24:27], a[88:91], a[188:191], v[24:27]
    buffer_load_dwordx4 v7, s[20:23], s44 offen offset:3072 lds
    v_mfma_f32_16x16x32_bf16 v[68:71], a[92:95], v[28:31], 0
    ds_read_b128 a[200:203], v15 offset:45056
    ds_read_b128 a[204:207], v15 offset:46080
    v_mfma_f32_16x16x32_bf16 v[72:75], a[96:99], v[28:31], 0
    global_load_dword v2, v[16:17], off
    v_mfma_f32_16x16x32_bf16 v[136:139], a[100:103], v[28:31], 0
    s_add_u32 m0, s34, 28672
    s_or_b32 s44, s32, s31
    buffer_load_dwordx4 v4, s[20:23], s44 offen offset:0 lds
    v_mfma_f32_16x16x32_bf16 v[140:143], a[104:107], v[28:31], 0
    v_exp_f32 v20, v20
    v_mfma_f32_16x16x32_bf16 v[144:147], a[108:111], v[28:31], 0
    v_exp_f32 v21, v21
    v_mfma_f32_16x16x32_bf16 v[148:151], a[112:115], v[28:31], 0
    v_exp_f32 v22, v22
    v_mfma_f32_16x16x32_bf16 v[152:155], a[116:119], v[28:31], 0
    s_barrier
    v_exp_f32 v23, v23
    v_mfma_f32_16x16x32_bf16 a[4:7], a[120:123], v[28:31], 0
    v_exp_f32 v24, v24
    v_mfma_f32_16x16x32_bf16 a[32:35], a[56:59], v[28:31], 0
    s_waitcnt lgkmcnt(0)
    v_cvt_pk_bf16_f32 v28, v20, v21
    v_cvt_pk_bf16_f32 v29, v22, v23
    v_mfma_f32_16x16x32_bf16 v[20:23], a[60:63], a[192:195], v[44:47]
    v_exp_f32 v25, v25
    v_mfma_f32_16x16x32_bf16 v[20:23], a[64:67], a[196:199], v[20:23]
    v_exp_f32 v26, v26
    v_mfma_f32_16x16x32_bf16 v[20:23], a[68:71], a[200:203], v[20:23]
    v_exp_f32 v27, v27
    v_mfma_f32_16x16x32_bf16 v[20:23], a[72:75], a[204:207], v[20:23]
    v_cvt_pk_bf16_f32 v30, v24, v25
    v_cvt_pk_bf16_f32 v31, v26, v27
    v_mfma_f32_16x16x32_bf16 v[24:27], a[76:79], a[192:195], v[44:47]
    buffer_load_dwordx4 v5, s[20:23], s44 offen offset:1024 lds
    v_mfma_f32_16x16x32_bf16 v[24:27], a[80:83], a[196:199], v[24:27]
    ds_read_b128 v[48:51], v19 offset:1024
    ds_read_b128 a[208:211], v14 offset:2048
    v_mfma_f32_16x16x32_bf16 v[24:27], a[84:87], a[200:203], v[24:27]
    ds_read_b128 a[212:215], v14 offset:3072
    v_mfma_f32_16x16x32_bf16 v[24:27], a[88:91], a[204:207], v[24:27]
    buffer_load_dwordx4 v6, s[20:23], s44 offen offset:2048 lds
    v_mfma_f32_16x16x32_bf16 v[76:79], a[92:95], v[28:31], 0
    ds_read_b128 a[216:219], v14 offset:6144
    ds_read_b128 a[220:223], v14 offset:7168
    v_mfma_f32_16x16x32_bf16 v[80:83], a[96:99], v[28:31], 0
    v_mfma_f32_16x16x32_bf16 v[156:159], a[100:103], v[28:31], 0
    buffer_load_dwordx4 v7, s[20:23], s44 offen offset:3072 lds
    v_mfma_f32_16x16x32_bf16 v[160:163], a[104:107], v[28:31], 0
    s_add_u32 s32, s32, 0x2000
    v_exp_f32 v20, v20
    v_mfma_f32_16x16x32_bf16 v[164:167], a[108:111], v[28:31], 0
    s_add_u32 m0, s34, 0
    v_exp_f32 v21, v21
    v_mfma_f32_16x16x32_bf16 v[168:171], a[112:115], v[28:31], 0
    s_or_b32 s44, s32, 0
    v_exp_f32 v22, v22
    v_mfma_f32_16x16x32_bf16 v[172:175], a[116:119], v[28:31], 0
    v_exp_f32 v23, v23
    v_mfma_f32_16x16x32_bf16 a[8:11], a[120:123], v[28:31], 0
    v_exp_f32 v24, v24
    v_mfma_f32_16x16x32_bf16 a[36:39], a[56:59], v[28:31], 0
    s_waitcnt lgkmcnt(0)
    v_cvt_pk_bf16_f32 v28, v20, v21
    v_cvt_pk_bf16_f32 v29, v22, v23
    v_mfma_f32_16x16x32_bf16 v[20:23], a[60:63], a[208:211], v[48:51]
    v_exp_f32 v25, v25
    v_mfma_f32_16x16x32_bf16 v[20:23], a[64:67], a[212:215], v[20:23]
    v_exp_f32 v26, v26
    v_mfma_f32_16x16x32_bf16 v[20:23], a[68:71], a[216:219], v[20:23]
    v_exp_f32 v27, v27
    v_mfma_f32_16x16x32_bf16 v[20:23], a[72:75], a[220:223], v[20:23]
    v_cvt_pk_bf16_f32 v30, v24, v25
    v_cvt_pk_bf16_f32 v31, v26, v27
    v_mfma_f32_16x16x32_bf16 v[24:27], a[76:79], a[208:211], v[48:51]
    buffer_load_dwordx4 v4, s[16:19], s44 offen offset:0 lds
    v_mfma_f32_16x16x32_bf16 v[24:27], a[80:83], a[212:215], v[24:27]
    ds_read_b128 v[52:55], v19 offset:1280
    ds_read_b128 a[224:227], v14 offset:43008
    v_mfma_f32_16x16x32_bf16 v[24:27], a[84:87], a[216:219], v[24:27]
    ds_read_b128 a[228:231], v14 offset:44032
    v_mfma_f32_16x16x32_bf16 v[24:27], a[88:91], a[220:223], v[24:27]
    buffer_load_dwordx4 v5, s[16:19], s44 offen offset:1024 lds
    v_mfma_f32_16x16x32_bf16 v[84:87], a[92:95], v[28:31], 0
    ds_read_b128 a[232:235], v14 offset:47104
    ds_read_b128 a[236:239], v14 offset:48128
    v_mfma_f32_16x16x32_bf16 v[88:91], a[96:99], v[28:31], 0
    v_mfma_f32_16x16x32_bf16 v[176:179], a[100:103], v[28:31], 0
    buffer_load_dwordx4 v6, s[16:19], s44 offen offset:2048 lds
    v_mfma_f32_16x16x32_bf16 v[180:183], a[104:107], v[28:31], 0
    v_exp_f32 v20, v20
    v_mfma_f32_16x16x32_bf16 v[184:187], a[108:111], v[28:31], 0
    v_exp_f32 v21, v21
    v_mfma_f32_16x16x32_bf16 v[188:191], a[112:115], v[28:31], 0
    v_exp_f32 v22, v22
    v_mfma_f32_16x16x32_bf16 v[192:195], a[116:119], v[28:31], 0
    v_exp_f32 v23, v23
    v_mfma_f32_16x16x32_bf16 a[12:15], a[120:123], v[28:31], 0
    v_exp_f32 v24, v24
    v_mfma_f32_16x16x32_bf16 a[40:43], a[56:59], v[28:31], 0
    s_waitcnt lgkmcnt(0)
    v_cvt_pk_bf16_f32 v28, v20, v21
    v_cvt_pk_bf16_f32 v29, v22, v23
    v_mfma_f32_16x16x32_bf16 v[20:23], a[60:63], a[224:227], v[52:55]
    v_exp_f32 v25, v25
    v_mfma_f32_16x16x32_bf16 v[20:23], a[64:67], a[228:231], v[20:23]
    v_exp_f32 v26, v26
    v_mfma_f32_16x16x32_bf16 v[20:23], a[68:71], a[232:235], v[20:23]
    v_exp_f32 v27, v27
    v_mfma_f32_16x16x32_bf16 v[20:23], a[72:75], a[236:239], v[20:23]
    v_cvt_pk_bf16_f32 v30, v24, v25
    v_cvt_pk_bf16_f32 v31, v26, v27
    v_mfma_f32_16x16x32_bf16 v[24:27], a[76:79], a[224:227], v[52:55]
    buffer_load_dwordx4 v7, s[16:19], s44 offen offset:3072 lds
    v_mfma_f32_16x16x32_bf16 v[24:27], a[80:83], a[228:231], v[24:27]
    ds_read_b128 v[56:59], v19 offset:1536
    ds_read_b128 a[240:243], v15 offset:2048
    v_mfma_f32_16x16x32_bf16 v[24:27], a[84:87], a[232:235], v[24:27]
    s_add_u32 m0, s34, 4096
    ds_read_b128 a[244:247], v15 offset:3072
    v_mfma_f32_16x16x32_bf16 v[24:27], a[88:91], a[236:239], v[24:27]
    s_or_b32 s44, s32, 128
    buffer_load_dwordx4 v4, s[16:19], s44 offen offset:0 lds
    v_mfma_f32_16x16x32_bf16 v[92:95], a[92:95], v[28:31], 0
    ds_read_b128 a[248:251], v15 offset:6144
    ds_read_b128 a[252:255], v15 offset:7168
    v_mfma_f32_16x16x32_bf16 v[96:99], a[96:99], v[28:31], 0
    v_mfma_f32_16x16x32_bf16 v[196:199], a[100:103], v[28:31], 0
    buffer_load_dwordx4 v5, s[16:19], s44 offen offset:1024 lds
    v_mfma_f32_16x16x32_bf16 v[200:203], a[104:107], v[28:31], 0
    v_exp_f32 v20, v20
    v_mfma_f32_16x16x32_bf16 v[204:207], a[108:111], v[28:31], 0
    v_exp_f32 v21, v21
    v_mfma_f32_16x16x32_bf16 v[208:211], a[112:115], v[28:31], 0
    v_exp_f32 v22, v22
    v_mfma_f32_16x16x32_bf16 v[212:215], a[116:119], v[28:31], 0
    v_exp_f32 v23, v23
    v_mfma_f32_16x16x32_bf16 a[16:19], a[120:123], v[28:31], 0
    v_exp_f32 v24, v24
    v_mfma_f32_16x16x32_bf16 a[44:47], a[56:59], v[28:31], 0
    s_waitcnt lgkmcnt(0)
    v_cvt_pk_bf16_f32 v28, v20, v21
    v_cvt_pk_bf16_f32 v29, v22, v23
    v_mfma_f32_16x16x32_bf16 v[20:23], a[60:63], a[240:243], v[56:59]
    v_exp_f32 v25, v25
    v_mfma_f32_16x16x32_bf16 v[20:23], a[64:67], a[244:247], v[20:23]
    v_exp_f32 v26, v26
    v_mfma_f32_16x16x32_bf16 v[20:23], a[68:71], a[248:251], v[20:23]
    v_exp_f32 v27, v27
    v_mfma_f32_16x16x32_bf16 v[20:23], a[72:75], a[252:255], v[20:23]
    s_waitcnt vmcnt(15)
    v_cvt_pk_bf16_f32 v30, v24, v25
    v_cvt_pk_bf16_f32 v31, v26, v27
    v_mfma_f32_16x16x32_bf16 v[24:27], a[76:79], a[240:243], v[56:59]
    ds_read_b128 a[60:63], v8 offset:8192
    ds_read_b128 a[64:67], v9 offset:8192
    v_mfma_f32_16x16x32_bf16 v[24:27], a[80:83], a[244:247], v[24:27]
    buffer_load_dwordx4 v6, s[16:19], s44 offen offset:2048 lds
    v_mfma_f32_16x16x32_bf16 v[24:27], a[84:87], a[248:251], v[24:27]
    ds_read_b128 a[68:71], v8 offset:12288
    ds_read_b128 a[72:75], v9 offset:12288
    v_mfma_f32_16x16x32_bf16 v[24:27], a[88:91], a[252:255], v[24:27]
    v_mfma_f32_16x16x32_bf16 v[100:103], a[92:95], v[28:31], 0
    ds_read_b128 a[76:79], v8 offset:10240
    ds_read_b128 a[80:83], v9 offset:10240
    v_mfma_f32_16x16x32_bf16 v[104:107], a[96:99], v[28:31], 0
    buffer_load_dwordx4 v7, s[16:19], s44 offen offset:3072 lds
    v_mfma_f32_16x16x32_bf16 v[216:219], a[100:103], v[28:31], 0
    ds_read_b128 a[84:87], v8 offset:14336
    ds_read_b128 a[88:91], v9 offset:14336
    v_mfma_f32_16x16x32_bf16 v[220:223], a[104:107], v[28:31], 0
    s_add_u32 m0, s34, 16384
    v_exp_f32 v20, v20
    v_mfma_f32_16x16x32_bf16 v[224:227], a[108:111], v[28:31], 0
    s_or_b32 s44, s32, s30
    v_exp_f32 v21, v21
    v_mfma_f32_16x16x32_bf16 v[228:231], a[112:115], v[28:31], 0
    v_exp_f32 v22, v22
    v_mfma_f32_16x16x32_bf16 v[232:235], a[116:119], v[28:31], 0
    v_exp_f32 v23, v23
    v_mfma_f32_16x16x32_bf16 a[20:23], a[120:123], v[28:31], 0
    v_exp_f32 v24, v24
    v_mfma_f32_16x16x32_bf16 a[48:51], a[56:59], v[28:31], 0
    s_waitcnt lgkmcnt(0)
    v_cvt_pk_bf16_f32 v28, v20, v21
    v_cvt_pk_bf16_f32 v29, v22, v23
    v_mfma_f32_16x16x32_bf16 v[20:23], a[60:63], a[144:147], v[32:35]
    v_exp_f32 v25, v25
    v_mfma_f32_16x16x32_bf16 v[20:23], a[64:67], a[148:151], v[20:23]
    v_exp_f32 v26, v26
    v_mfma_f32_16x16x32_bf16 v[20:23], a[68:71], a[152:155], v[20:23]
    v_exp_f32 v27, v27
    v_mfma_f32_16x16x32_bf16 v[20:23], a[72:75], a[156:159], v[20:23]
    v_cvt_pk_bf16_f32 v30, v24, v25
    v_cvt_pk_bf16_f32 v31, v26, v27
    v_mfma_f32_16x16x32_bf16 v[24:27], a[76:79], a[144:147], v[32:35]
    buffer_load_dwordx4 v4, s[20:23], s44 offen offset:0 lds
    v_mfma_f32_16x16x32_bf16 v[24:27], a[80:83], a[148:151], v[24:27]
    s_waitcnt vmcnt(14)
    v_mfma_f32_16x16x32_bf16 v[24:27], a[84:87], a[152:155], v[24:27]
    ds_read_b64_tr_b16 a[124:125], v13 offset:24576
    ds_read_b64_tr_b16 a[126:127], v13 offset:26624
    v_mfma_f32_16x16x32_bf16 v[24:27], a[88:91], a[156:159], v[24:27]
    buffer_load_dwordx4 v5, s[20:23], s44 offen offset:1024 lds
    v_mfma_f32_16x16x32_bf16 v[108:111], a[92:95], v[28:31], 0
    ds_read_b64_tr_b16 a[92:93], v10 offset:24576
    ds_read_b64_tr_b16 a[94:95], v10 offset:26624
    v_mfma_f32_16x16x32_bf16 v[112:115], a[96:99], v[28:31], 0
    ds_read_b64_tr_b16 a[96:97], v11 offset:24576
    ds_read_b64_tr_b16 a[98:99], v11 offset:26624
    v_mfma_f32_16x16x32_bf16 v[236:239], a[100:103], v[28:31], 0
    ds_read_b64_tr_b16 a[100:101], v12 offset:24576
    ds_read_b64_tr_b16 a[102:103], v12 offset:26624
    v_mfma_f32_16x16x32_bf16 v[240:243], a[104:107], v[28:31], 0
    v_exp_f32 v20, v20
    v_mfma_f32_16x16x32_bf16 v[244:247], a[108:111], v[28:31], 0
    v_exp_f32 v21, v21
    v_mfma_f32_16x16x32_bf16 v[248:251], a[112:115], v[28:31], 0
    v_exp_f32 v22, v22
    v_mfma_f32_16x16x32_bf16 v[252:255], a[116:119], v[28:31], 0
    v_exp_f32 v23, v23
    v_mfma_f32_16x16x32_bf16 a[24:27], a[120:123], v[28:31], 0
    v_exp_f32 v24, v24
    v_mfma_f32_16x16x32_bf16 a[52:55], a[56:59], v[28:31], 0
    v_cvt_pk_bf16_f32 v28, v20, v21
    v_cvt_pk_bf16_f32 v29, v22, v23
    s_mov_b32 s35, 3
.p2align 3
L_loop:
    v_mfma_f32_16x16x32_bf16 v[20:23], a[60:63], a[160:163], v[36:39]
    v_exp_f32 v25, v25
    v_mfma_f32_16x16x32_bf16 v[20:23], a[64:67], a[164:167], v[20:23]
    v_exp_f32 v26, v26
    v_mfma_f32_16x16x32_bf16 v[20:23], a[68:71], a[168:171], v[20:23]
    s_waitcnt lgkmcnt(0)
    v_exp_f32 v27, v27
    v_mfma_f32_16x16x32_bf16 v[20:23], a[72:75], a[172:175], v[20:23]
    s_waitcnt vmcnt(10)
    v_cvt_pk_bf16_f32 v30, v24, v25
    v_cvt_pk_bf16_f32 v31, v26, v27
    v_mfma_f32_16x16x32_bf16 v[24:27], a[76:79], a[160:163], v[36:39]
    ds_read_b64_tr_b16 a[108:109], v10 offset:28672
    ds_read_b64_tr_b16 a[110:111], v10 offset:30720
    v_mfma_f32_16x16x32_bf16 v[24:27], a[80:83], a[164:167], v[24:27]
    ds_read_b64_tr_b16 a[112:113], v11 offset:28672
    ds_read_b64_tr_b16 a[114:115], v11 offset:30720
    v_mfma_f32_16x16x32_bf16 v[24:27], a[84:87], a[168:171], v[24:27]
    ds_read_b64_tr_b16 a[116:117], v12 offset:28672
    ds_read_b64_tr_b16 a[118:119], v12 offset:30720
    v_mfma_f32_16x16x32_bf16 v[24:27], a[88:91], a[172:175], v[24:27]
    ds_read_b64_tr_b16 a[120:121], v13 offset:28672
    ds_read_b64_tr_b16 a[122:123], v13 offset:30720
    v_mfma_f32_16x16x32_bf16 v[60:63], a[92:95], v[28:31], v[60:63]
    buffer_load_dwordx4 v6, s[20:23], s44 offen offset:2048 lds
    v_mfma_f32_16x16x32_bf16 v[64:67], a[96:99], v[28:31], v[64:67]
    v_mfma_f32_16x16x32_bf16 v[116:119], a[100:103], v[28:31], v[116:119]
    buffer_load_dwordx4 v7, s[20:23], s44 offen offset:3072 lds
    v_mfma_f32_16x16x32_bf16 v[120:123], a[124:127], v[28:31], v[120:123]
    s_waitcnt lgkmcnt(4)
    v_exp_f32 v20, v20
    v_mfma_f32_16x16x32_bf16 v[124:127], a[108:111], v[28:31], v[124:127]
    s_add_u32 m0, s34, 20480
    v_exp_f32 v21, v21
    v_mfma_f32_16x16x32_bf16 v[128:131], a[112:115], v[28:31], v[128:131]
    s_waitcnt lgkmcnt(0)
    v_exp_f32 v22, v22
    v_mfma_f32_16x16x32_bf16 v[132:135], a[116:119], v[28:31], v[132:135]
    s_or_b32 s44, s32, s31
    v_exp_f32 v23, v23
    v_mfma_f32_16x16x32_bf16 a[0:3], a[120:123], v[28:31], a[0:3]
    v_exp_f32 v24, v24
    v_mfma_f32_16x16x32_bf16 a[28:31], a[56:59], v[28:31], a[28:31]
    v_cvt_pk_bf16_f32 v28, v20, v21
    v_cvt_pk_bf16_f32 v29, v22, v23
    v_mfma_f32_16x16x32_bf16 v[20:23], a[60:63], a[176:179], v[40:43]
    v_exp_f32 v25, v25
    v_mfma_f32_16x16x32_bf16 v[20:23], a[64:67], a[180:183], v[20:23]
    v_exp_f32 v26, v26
    v_mfma_f32_16x16x32_bf16 v[20:23], a[68:71], a[184:187], v[20:23]
    v_exp_f32 v27, v27
    v_mfma_f32_16x16x32_bf16 v[20:23], a[72:75], a[188:191], v[20:23]
    v_cvt_pk_bf16_f32 v30, v24, v25
    v_cvt_pk_bf16_f32 v31, v26, v27
    v_mfma_f32_16x16x32_bf16 v[24:27], a[76:79], a[176:179], v[40:43]
    buffer_load_dwordx4 v4, s[20:23], s44 offen offset:0 lds
    v_mfma_f32_16x16x32_bf16 v[24:27], a[80:83], a[180:183], v[24:27]
    v_mfma_f32_16x16x32_bf16 v[24:27], a[84:87], a[184:187], v[24:27]
    v_mfma_f32_16x16x32_bf16 v[24:27], a[88:91], a[188:191], v[24:27]
    v_mfma_f32_16x16x32_bf16 v[68:71], a[92:95], v[28:31], v[68:71]
    v_mfma_f32_16x16x32_bf16 v[72:75], a[96:99], v[28:31], v[72:75]
    v_mfma_f32_16x16x32_bf16 v[136:139], a[100:103], v[28:31], v[136:139]
    buffer_load_dwordx4 v5, s[20:23], s44 offen offset:1024 lds
    v_mfma_f32_16x16x32_bf16 v[140:143], a[124:127], v[28:31], v[140:143]
    v_exp_f32 v20, v20
    v_mfma_f32_16x16x32_bf16 v[144:147], a[108:111], v[28:31], v[144:147]
    v_exp_f32 v21, v21
    v_mfma_f32_16x16x32_bf16 v[148:151], a[112:115], v[28:31], v[148:151]
    v_exp_f32 v22, v22
    v_mfma_f32_16x16x32_bf16 v[152:155], a[116:119], v[28:31], v[152:155]
    v_exp_f32 v23, v23
    v_mfma_f32_16x16x32_bf16 a[4:7], a[120:123], v[28:31], a[4:7]
    v_exp_f32 v24, v24
    v_mfma_f32_16x16x32_bf16 a[32:35], a[56:59], v[28:31], a[32:35]
    v_cvt_pk_bf16_f32 v28, v20, v21
    v_cvt_pk_bf16_f32 v29, v22, v23
    v_mfma_f32_16x16x32_bf16 v[20:23], a[60:63], a[192:195], v[44:47]
    v_exp_f32 v25, v25
    v_mfma_f32_16x16x32_bf16 v[20:23], a[64:67], a[196:199], v[20:23]
    v_exp_f32 v26, v26
    v_mfma_f32_16x16x32_bf16 v[20:23], a[68:71], a[200:203], v[20:23]
    v_exp_f32 v27, v27
    v_mfma_f32_16x16x32_bf16 v[20:23], a[72:75], a[204:207], v[20:23]
    v_cvt_pk_bf16_f32 v30, v24, v25
    v_cvt_pk_bf16_f32 v31, v26, v27
    v_mfma_f32_16x16x32_bf16 v[24:27], a[76:79], a[192:195], v[44:47]
    buffer_load_dwordx4 v6, s[20:23], s44 offen offset:2048 lds
    v_mfma_f32_16x16x32_bf16 v[24:27], a[80:83], a[196:199], v[24:27]
    v_mfma_f32_16x16x32_bf16 v[24:27], a[84:87], a[200:203], v[24:27]
    v_mfma_f32_16x16x32_bf16 v[24:27], a[88:91], a[204:207], v[24:27]
    buffer_load_dwordx4 v7, s[20:23], s44 offen offset:3072 lds
    v_mfma_f32_16x16x32_bf16 v[76:79], a[92:95], v[28:31], v[76:79]
    s_add_u32 s32, s32, 0x2000
    s_add_u32 m0, s34, 8192
    v_mfma_f32_16x16x32_bf16 v[80:83], a[96:99], v[28:31], v[80:83]
    s_or_b32 s44, s32, 0
    v_mfma_f32_16x16x32_bf16 v[156:159], a[100:103], v[28:31], v[156:159]
    buffer_load_dwordx4 v4, s[16:19], s44 offen offset:0 lds
    v_mfma_f32_16x16x32_bf16 v[160:163], a[124:127], v[28:31], v[160:163]
    v_exp_f32 v20, v20
    v_mfma_f32_16x16x32_bf16 v[164:167], a[108:111], v[28:31], v[164:167]
    v_exp_f32 v21, v21
    v_mfma_f32_16x16x32_bf16 v[168:171], a[112:115], v[28:31], v[168:171]
    v_exp_f32 v22, v22
    v_mfma_f32_16x16x32_bf16 v[172:175], a[116:119], v[28:31], v[172:175]
    v_exp_f32 v23, v23
    v_mfma_f32_16x16x32_bf16 a[8:11], a[120:123], v[28:31], a[8:11]
    v_exp_f32 v24, v24
    v_mfma_f32_16x16x32_bf16 a[36:39], a[56:59], v[28:31], a[36:39]
    v_cvt_pk_bf16_f32 v28, v20, v21
    v_cvt_pk_bf16_f32 v29, v22, v23
    v_mfma_f32_16x16x32_bf16 v[20:23], a[60:63], a[208:211], v[48:51]
    v_exp_f32 v25, v25
    v_mfma_f32_16x16x32_bf16 v[20:23], a[64:67], a[212:215], v[20:23]
    v_exp_f32 v26, v26
    v_mfma_f32_16x16x32_bf16 v[20:23], a[68:71], a[216:219], v[20:23]
    v_exp_f32 v27, v27
    v_mfma_f32_16x16x32_bf16 v[20:23], a[72:75], a[220:223], v[20:23]
    v_cvt_pk_bf16_f32 v30, v24, v25
    v_cvt_pk_bf16_f32 v31, v26, v27
    v_mfma_f32_16x16x32_bf16 v[24:27], a[76:79], a[208:211], v[48:51]
    buffer_load_dwordx4 v5, s[16:19], s44 offen offset:1024 lds
    v_mfma_f32_16x16x32_bf16 v[24:27], a[80:83], a[212:215], v[24:27]
    v_mfma_f32_16x16x32_bf16 v[24:27], a[84:87], a[216:219], v[24:27]
    v_mfma_f32_16x16x32_bf16 v[24:27], a[88:91], a[220:223], v[24:27]
    v_mfma_f32_16x16x32_bf16 v[84:87], a[92:95], v[28:31], v[84:87]
    v_mfma_f32_16x16x32_bf16 v[88:91], a[96:99], v[28:31], v[88:91]
    v_mfma_f32_16x16x32_bf16 v[176:179], a[100:103], v[28:31], v[176:179]
    buffer_load_dwordx4 v6, s[16:19], s44 offen offset:2048 lds
    v_mfma_f32_16x16x32_bf16 v[180:183], a[124:127], v[28:31], v[180:183]
    v_exp_f32 v20, v20
    v_mfma_f32_16x16x32_bf16 v[184:187], a[108:111], v[28:31], v[184:187]
    v_exp_f32 v21, v21
    v_mfma_f32_16x16x32_bf16 v[188:191], a[112:115], v[28:31], v[188:191]
    v_exp_f32 v22, v22
    v_mfma_f32_16x16x32_bf16 v[192:195], a[116:119], v[28:31], v[192:195]
    v_exp_f32 v23, v23
    v_mfma_f32_16x16x32_bf16 a[12:15], a[120:123], v[28:31], a[12:15]
    v_exp_f32 v24, v24
    v_mfma_f32_16x16x32_bf16 a[40:43], a[56:59], v[28:31], a[40:43]
    v_cvt_pk_bf16_f32 v28, v20, v21
    v_cvt_pk_bf16_f32 v29, v22, v23
    v_mfma_f32_16x16x32_bf16 v[20:23], a[60:63], a[224:227], v[52:55]
    v_exp_f32 v25, v25
    v_mfma_f32_16x16x32_bf16 v[20:23], a[64:67], a[228:231], v[20:23]
    v_exp_f32 v26, v26
    v_mfma_f32_16x16x32_bf16 v[20:23], a[68:71], a[232:235], v[20:23]
    v_exp_f32 v27, v27
    v_mfma_f32_16x16x32_bf16 v[20:23], a[72:75], a[236:239], v[20:23]
    v_cvt_pk_bf16_f32 v30, v24, v25
    v_cvt_pk_bf16_f32 v31, v26, v27
    v_mfma_f32_16x16x32_bf16 v[24:27], a[76:79], a[224:227], v[52:55]
    buffer_load_dwordx4 v7, s[16:19], s44 offen offset:3072 lds
    v_mfma_f32_16x16x32_bf16 v[24:27], a[80:83], a[228:231], v[24:27]
    s_add_u32 m0, s34, 12288
    s_or_b32 s44, s32, 128
    v_mfma_f32_16x16x32_bf16 v[24:27], a[84:87], a[232:235], v[24:27]
    v_mfma_f32_16x16x32_bf16 v[24:27], a[88:91], a[236:239], v[24:27]
    buffer_load_dwordx4 v4, s[16:19], s44 offen offset:0 lds
    v_mfma_f32_16x16x32_bf16 v[92:95], a[92:95], v[28:31], v[92:95]
    v_mfma_f32_16x16x32_bf16 v[96:99], a[96:99], v[28:31], v[96:99]
    v_mfma_f32_16x16x32_bf16 v[196:199], a[100:103], v[28:31], v[196:199]
    buffer_load_dwordx4 v5, s[16:19], s44 offen offset:1024 lds
    v_mfma_f32_16x16x32_bf16 v[200:203], a[124:127], v[28:31], v[200:203]
    v_exp_f32 v20, v20
    v_mfma_f32_16x16x32_bf16 v[204:207], a[108:111], v[28:31], v[204:207]
    v_exp_f32 v21, v21
    v_mfma_f32_16x16x32_bf16 v[208:211], a[112:115], v[28:31], v[208:211]
    v_exp_f32 v22, v22
    v_mfma_f32_16x16x32_bf16 v[212:215], a[116:119], v[28:31], v[212:215]
    v_exp_f32 v23, v23
    v_mfma_f32_16x16x32_bf16 a[16:19], a[120:123], v[28:31], a[16:19]
    v_exp_f32 v24, v24
    v_mfma_f32_16x16x32_bf16 a[44:47], a[56:59], v[28:31], a[44:47]
    v_cvt_pk_bf16_f32 v28, v20, v21
    v_cvt_pk_bf16_f32 v29, v22, v23
    v_mfma_f32_16x16x32_bf16 v[20:23], a[60:63], a[240:243], v[56:59]
    v_exp_f32 v25, v25
    v_mfma_f32_16x16x32_bf16 v[20:23], a[64:67], a[244:247], v[20:23]
    v_exp_f32 v26, v26
    v_mfma_f32_16x16x32_bf16 v[20:23], a[68:71], a[248:251], v[20:23]
    v_exp_f32 v27, v27
    v_mfma_f32_16x16x32_bf16 v[20:23], a[72:75], a[252:255], v[20:23]
    s_waitcnt vmcnt(14)
    v_cvt_pk_bf16_f32 v30, v24, v25
    v_cvt_pk_bf16_f32 v31, v26, v27
    v_mfma_f32_16x16x32_bf16 v[24:27], a[76:79], a[240:243], v[56:59]
    ds_read_b128 a[60:63], v8 offset:0
    ds_read_b128 a[64:67], v9 offset:0
    v_mfma_f32_16x16x32_bf16 v[24:27], a[80:83], a[244:247], v[24:27]
    buffer_load_dwordx4 v6, s[16:19], s44 offen offset:2048 lds
    v_mfma_f32_16x16x32_bf16 v[24:27], a[84:87], a[248:251], v[24:27]
    ds_read_b128 a[68:71], v8 offset:4096
    ds_read_b128 a[72:75], v9 offset:4096
    v_mfma_f32_16x16x32_bf16 v[24:27], a[88:91], a[252:255], v[24:27]
    v_mfma_f32_16x16x32_bf16 v[100:103], a[92:95], v[28:31], v[100:103]
    ds_read_b128 a[76:79], v8 offset:2048
    ds_read_b128 a[80:83], v9 offset:2048
    v_mfma_f32_16x16x32_bf16 v[104:107], a[96:99], v[28:31], v[104:107]
    buffer_load_dwordx4 v7, s[16:19], s44 offen offset:3072 lds
    v_mfma_f32_16x16x32_bf16 v[216:219], a[100:103], v[28:31], v[216:219]
    ds_read_b128 a[84:87], v8 offset:6144
    ds_read_b128 a[88:91], v9 offset:6144
    v_mfma_f32_16x16x32_bf16 v[220:223], a[124:127], v[28:31], v[220:223]
    s_add_u32 m0, s34, 24576
    v_exp_f32 v20, v20
    v_mfma_f32_16x16x32_bf16 v[224:227], a[108:111], v[28:31], v[224:227]
    s_or_b32 s44, s32, s30
    v_exp_f32 v21, v21
    v_mfma_f32_16x16x32_bf16 v[228:231], a[112:115], v[28:31], v[228:231]
    v_exp_f32 v22, v22
    v_mfma_f32_16x16x32_bf16 v[232:235], a[116:119], v[28:31], v[232:235]
    v_exp_f32 v23, v23
    v_mfma_f32_16x16x32_bf16 a[20:23], a[120:123], v[28:31], a[20:23]
    v_exp_f32 v24, v24
    v_mfma_f32_16x16x32_bf16 a[48:51], a[56:59], v[28:31], a[48:51]
    s_waitcnt lgkmcnt(0)
    v_cvt_pk_bf16_f32 v28, v20, v21
    v_cvt_pk_bf16_f32 v29, v22, v23
    v_mfma_f32_16x16x32_bf16 v[20:23], a[60:63], a[144:147], v[32:35]
    v_exp_f32 v25, v25
    v_mfma_f32_16x16x32_bf16 v[20:23], a[64:67], a[148:151], v[20:23]
    v_exp_f32 v26, v26
    v_mfma_f32_16x16x32_bf16 v[20:23], a[68:71], a[152:155], v[20:23]
    v_exp_f32 v27, v27
    v_mfma_f32_16x16x32_bf16 v[20:23], a[72:75], a[156:159], v[20:23]
    v_cvt_pk_bf16_f32 v30, v24, v25
    v_cvt_pk_bf16_f32 v31, v26, v27
    v_mfma_f32_16x16x32_bf16 v[24:27], a[76:79], a[144:147], v[32:35]
    buffer_load_dwordx4 v4, s[20:23], s44 offen offset:0 lds
    v_mfma_f32_16x16x32_bf16 v[24:27], a[80:83], a[148:151], v[24:27]
    s_waitcnt vmcnt(13)
    v_mfma_f32_16x16x32_bf16 v[24:27], a[84:87], a[152:155], v[24:27]
    ds_read_b64_tr_b16 a[104:105], v13 offset:16384
    ds_read_b64_tr_b16 a[106:107], v13 offset:18432
    v_mfma_f32_16x16x32_bf16 v[24:27], a[88:91], a[156:159], v[24:27]
    buffer_load_dwordx4 v5, s[20:23], s44 offen offset:1024 lds
    v_mfma_f32_16x16x32_bf16 v[108:111], a[92:95], v[28:31], v[108:111]
    ds_read_b64_tr_b16 a[92:93], v10 offset:16384
    ds_read_b64_tr_b16 a[94:95], v10 offset:18432
    v_mfma_f32_16x16x32_bf16 v[112:115], a[96:99], v[28:31], v[112:115]
    ds_read_b64_tr_b16 a[96:97], v11 offset:16384
    ds_read_b64_tr_b16 a[98:99], v11 offset:18432
    v_mfma_f32_16x16x32_bf16 v[236:239], a[100:103], v[28:31], v[236:239]
    ds_read_b64_tr_b16 a[100:101], v12 offset:16384
    ds_read_b64_tr_b16 a[102:103], v12 offset:18432
    v_mfma_f32_16x16x32_bf16 v[240:243], a[124:127], v[28:31], v[240:243]
    v_exp_f32 v20, v20
    v_mfma_f32_16x16x32_bf16 v[244:247], a[108:111], v[28:31], v[244:247]
    v_exp_f32 v21, v21
    v_mfma_f32_16x16x32_bf16 v[248:251], a[112:115], v[28:31], v[248:251]
    v_exp_f32 v22, v22
    v_mfma_f32_16x16x32_bf16 v[252:255], a[116:119], v[28:31], v[252:255]
    v_exp_f32 v23, v23
    v_mfma_f32_16x16x32_bf16 a[24:27], a[120:123], v[28:31], a[24:27]
    v_exp_f32 v24, v24
    v_mfma_f32_16x16x32_bf16 a[52:55], a[56:59], v[28:31], a[52:55]
    v_cvt_pk_bf16_f32 v28, v20, v21
    v_cvt_pk_bf16_f32 v29, v22, v23
    v_mfma_f32_16x16x32_bf16 v[20:23], a[60:63], a[160:163], v[36:39]
    v_exp_f32 v25, v25
    v_mfma_f32_16x16x32_bf16 v[20:23], a[64:67], a[164:167], v[20:23]
    v_exp_f32 v26, v26
    v_mfma_f32_16x16x32_bf16 v[20:23], a[68:71], a[168:171], v[20:23]
    s_waitcnt lgkmcnt(0)
    v_exp_f32 v27, v27
    v_mfma_f32_16x16x32_bf16 v[20:23], a[72:75], a[172:175], v[20:23]
    s_waitcnt vmcnt(10)
    v_cvt_pk_bf16_f32 v30, v24, v25
    v_cvt_pk_bf16_f32 v31, v26, v27
    v_mfma_f32_16x16x32_bf16 v[24:27], a[76:79], a[160:163], v[36:39]
    ds_read_b64_tr_b16 a[108:109], v10 offset:20480
    ds_read_b64_tr_b16 a[110:111], v10 offset:22528
    v_mfma_f32_16x16x32_bf16 v[24:27], a[80:83], a[164:167], v[24:27]
    ds_read_b64_tr_b16 a[112:113], v11 offset:20480
    ds_read_b64_tr_b16 a[114:115], v11 offset:22528
    v_mfma_f32_16x16x32_bf16 v[24:27], a[84:87], a[168:171], v[24:27]
    ds_read_b64_tr_b16 a[116:117], v12 offset:20480
    ds_read_b64_tr_b16 a[118:119], v12 offset:22528
    v_mfma_f32_16x16x32_bf16 v[24:27], a[88:91], a[172:175], v[24:27]
    ds_read_b64_tr_b16 a[120:121], v13 offset:20480
    ds_read_b64_tr_b16 a[122:123], v13 offset:22528
    v_mfma_f32_16x16x32_bf16 v[60:63], a[92:95], v[28:31], v[60:63]
    buffer_load_dwordx4 v6, s[20:23], s44 offen offset:2048 lds
    v_mfma_f32_16x16x32_bf16 v[64:67], a[96:99], v[28:31], v[64:67]
    v_mfma_f32_16x16x32_bf16 v[116:119], a[100:103], v[28:31], v[116:119]
    buffer_load_dwordx4 v7, s[20:23], s44 offen offset:3072 lds
    v_mfma_f32_16x16x32_bf16 v[120:123], a[104:107], v[28:31], v[120:123]
    s_waitcnt lgkmcnt(4)
    v_exp_f32 v20, v20
    v_mfma_f32_16x16x32_bf16 v[124:127], a[108:111], v[28:31], v[124:127]
    s_add_u32 m0, s34, 28672
    v_exp_f32 v21, v21
    v_mfma_f32_16x16x32_bf16 v[128:131], a[112:115], v[28:31], v[128:131]
    s_waitcnt lgkmcnt(0)
    v_exp_f32 v22, v22
    v_mfma_f32_16x16x32_bf16 v[132:135], a[116:119], v[28:31], v[132:135]
    s_or_b32 s44, s32, s31
    v_exp_f32 v23, v23
    v_mfma_f32_16x16x32_bf16 a[0:3], a[120:123], v[28:31], a[0:3]
    v_exp_f32 v24, v24
    v_mfma_f32_16x16x32_bf16 a[28:31], a[56:59], v[28:31], a[28:31]
    v_cvt_pk_bf16_f32 v28, v20, v21
    v_cvt_pk_bf16_f32 v29, v22, v23
    v_mfma_f32_16x16x32_bf16 v[20:23], a[60:63], a[176:179], v[40:43]
    v_exp_f32 v25, v25
    v_mfma_f32_16x16x32_bf16 v[20:23], a[64:67], a[180:183], v[20:23]
    v_exp_f32 v26, v26
    v_mfma_f32_16x16x32_bf16 v[20:23], a[68:71], a[184:187], v[20:23]
    v_exp_f32 v27, v27
    v_mfma_f32_16x16x32_bf16 v[20:23], a[72:75], a[188:191], v[20:23]
    v_cvt_pk_bf16_f32 v30, v24, v25
    v_cvt_pk_bf16_f32 v31, v26, v27
    v_mfma_f32_16x16x32_bf16 v[24:27], a[76:79], a[176:179], v[40:43]
    buffer_load_dwordx4 v4, s[20:23], s44 offen offset:0 lds
    v_mfma_f32_16x16x32_bf16 v[24:27], a[80:83], a[180:183], v[24:27]
    v_mfma_f32_16x16x32_bf16 v[24:27], a[84:87], a[184:187], v[24:27]
    v_mfma_f32_16x16x32_bf16 v[24:27], a[88:91], a[188:191], v[24:27]
    global_load_dword v2, v[16:17], off
    v_mfma_f32_16x16x32_bf16 v[68:71], a[92:95], v[28:31], v[68:71]
    v_mfma_f32_16x16x32_bf16 v[72:75], a[96:99], v[28:31], v[72:75]
    v_mfma_f32_16x16x32_bf16 v[136:139], a[100:103], v[28:31], v[136:139]
    buffer_load_dwordx4 v5, s[20:23], s44 offen offset:1024 lds
    v_mfma_f32_16x16x32_bf16 v[140:143], a[104:107], v[28:31], v[140:143]
    v_exp_f32 v20, v20
    v_mfma_f32_16x16x32_bf16 v[144:147], a[108:111], v[28:31], v[144:147]
    v_exp_f32 v21, v21
    v_mfma_f32_16x16x32_bf16 v[148:151], a[112:115], v[28:31], v[148:151]
    v_exp_f32 v22, v22
    v_mfma_f32_16x16x32_bf16 v[152:155], a[116:119], v[28:31], v[152:155]
    v_exp_f32 v23, v23
    v_mfma_f32_16x16x32_bf16 a[4:7], a[120:123], v[28:31], a[4:7]
    v_exp_f32 v24, v24
    v_mfma_f32_16x16x32_bf16 a[32:35], a[56:59], v[28:31], a[32:35]
    v_cvt_pk_bf16_f32 v28, v20, v21
    v_cvt_pk_bf16_f32 v29, v22, v23
    v_mfma_f32_16x16x32_bf16 v[20:23], a[60:63], a[192:195], v[44:47]
    v_exp_f32 v25, v25
    v_mfma_f32_16x16x32_bf16 v[20:23], a[64:67], a[196:199], v[20:23]
    v_exp_f32 v26, v26
    v_mfma_f32_16x16x32_bf16 v[20:23], a[68:71], a[200:203], v[20:23]
    v_exp_f32 v27, v27
    v_mfma_f32_16x16x32_bf16 v[20:23], a[72:75], a[204:207], v[20:23]
    v_cvt_pk_bf16_f32 v30, v24, v25
    v_cvt_pk_bf16_f32 v31, v26, v27
    v_mfma_f32_16x16x32_bf16 v[24:27], a[76:79], a[192:195], v[44:47]
    buffer_load_dwordx4 v6, s[20:23], s44 offen offset:2048 lds
    v_mfma_f32_16x16x32_bf16 v[24:27], a[80:83], a[196:199], v[24:27]
    v_mfma_f32_16x16x32_bf16 v[24:27], a[84:87], a[200:203], v[24:27]
    v_mfma_f32_16x16x32_bf16 v[24:27], a[88:91], a[204:207], v[24:27]
    buffer_load_dwordx4 v7, s[20:23], s44 offen offset:3072 lds
    v_mfma_f32_16x16x32_bf16 v[76:79], a[92:95], v[28:31], v[76:79]
    s_add_u32 s32, s32, 0x2000
    s_cmp_lt_u32 s32, 0x10000
    v_mfma_f32_16x16x32_bf16 v[80:83], a[96:99], v[28:31], v[80:83]
    s_cselect_b32 s18, 0x10000, 0
    s_mov_b32 s22, s18
    v_mfma_f32_16x16x32_bf16 v[156:159], a[100:103], v[28:31], v[156:159]
    s_add_u32 m0, s34, 0
    s_or_b32 s44, s32, 0
    buffer_load_dwordx4 v4, s[16:19], s44 offen offset:0 lds
    v_mfma_f32_16x16x32_bf16 v[160:163], a[104:107], v[28:31], v[160:163]
    v_exp_f32 v20, v20
    v_mfma_f32_16x16x32_bf16 v[164:167], a[108:111], v[28:31], v[164:167]
    v_exp_f32 v21, v21
    v_mfma_f32_16x16x32_bf16 v[168:171], a[112:115], v[28:31], v[168:171]
    v_exp_f32 v22, v22
    v_mfma_f32_16x16x32_bf16 v[172:175], a[116:119], v[28:31], v[172:175]
    v_exp_f32 v23, v23
    v_mfma_f32_16x16x32_bf16 a[8:11], a[120:123], v[28:31], a[8:11]
    v_exp_f32 v24, v24
    v_mfma_f32_16x16x32_bf16 a[36:39], a[56:59], v[28:31], a[36:39]
    v_cvt_pk_bf16_f32 v28, v20, v21
    v_cvt_pk_bf16_f32 v29, v22, v23
    v_mfma_f32_16x16x32_bf16 v[20:23], a[60:63], a[208:211], v[48:51]
    v_exp_f32 v25, v25
    v_mfma_f32_16x16x32_bf16 v[20:23], a[64:67], a[212:215], v[20:23]
    v_exp_f32 v26, v26
    v_mfma_f32_16x16x32_bf16 v[20:23], a[68:71], a[216:219], v[20:23]
    v_exp_f32 v27, v27
    v_mfma_f32_16x16x32_bf16 v[20:23], a[72:75], a[220:223], v[20:23]
    v_cvt_pk_bf16_f32 v30, v24, v25
    v_cvt_pk_bf16_f32 v31, v26, v27
    v_mfma_f32_16x16x32_bf16 v[24:27], a[76:79], a[208:211], v[48:51]
    buffer_load_dwordx4 v5, s[16:19], s44 offen offset:1024 lds
    v_mfma_f32_16x16x32_bf16 v[24:27], a[80:83], a[212:215], v[24:27]
    v_mfma_f32_16x16x32_bf16 v[24:27], a[84:87], a[216:219], v[24:27]
    v_mfma_f32_16x16x32_bf16 v[24:27], a[88:91], a[220:223], v[24:27]
    v_mfma_f32_16x16x32_bf16 v[84:87], a[92:95], v[28:31], v[84:87]
    v_mfma_f32_16x16x32_bf16 v[88:91], a[96:99], v[28:31], v[88:91]
    v_mfma_f32_16x16x32_bf16 v[176:179], a[100:103], v[28:31], v[176:179]
    buffer_load_dwordx4 v6, s[16:19], s44 offen offset:2048 lds
    v_mfma_f32_16x16x32_bf16 v[180:183], a[104:107], v[28:31], v[180:183]
    v_exp_f32 v20, v20
    v_mfma_f32_16x16x32_bf16 v[184:187], a[108:111], v[28:31], v[184:187]
    v_exp_f32 v21, v21
    v_mfma_f32_16x16x32_bf16 v[188:191], a[112:115], v[28:31], v[188:191]
    v_exp_f32 v22, v22
    v_mfma_f32_16x16x32_bf16 v[192:195], a[116:119], v[28:31], v[192:195]
    v_exp_f32 v23, v23
    v_mfma_f32_16x16x32_bf16 a[12:15], a[120:123], v[28:31], a[12:15]
    v_exp_f32 v24, v24
    v_mfma_f32_16x16x32_bf16 a[40:43], a[56:59], v[28:31], a[40:43]
    v_cvt_pk_bf16_f32 v28, v20, v21
    v_cvt_pk_bf16_f32 v29, v22, v23
    v_mfma_f32_16x16x32_bf16 v[20:23], a[60:63], a[224:227], v[52:55]
    v_exp_f32 v25, v25
    v_mfma_f32_16x16x32_bf16 v[20:23], a[64:67], a[228:231], v[20:23]
    v_exp_f32 v26, v26
    v_mfma_f32_16x16x32_bf16 v[20:23], a[68:71], a[232:235], v[20:23]
    v_exp_f32 v27, v27
    v_mfma_f32_16x16x32_bf16 v[20:23], a[72:75], a[236:239], v[20:23]
    v_cvt_pk_bf16_f32 v30, v24, v25
    v_cvt_pk_bf16_f32 v31, v26, v27
    v_mfma_f32_16x16x32_bf16 v[24:27], a[76:79], a[224:227], v[52:55]
    buffer_load_dwordx4 v7, s[16:19], s44 offen offset:3072 lds
    v_mfma_f32_16x16x32_bf16 v[24:27], a[80:83], a[228:231], v[24:27]
    s_add_u32 m0, s34, 4096
    s_or_b32 s44, s32, 128
    v_mfma_f32_16x16x32_bf16 v[24:27], a[84:87], a[232:235], v[24:27]
    v_mfma_f32_16x16x32_bf16 v[24:27], a[88:91], a[236:239], v[24:27]
    buffer_load_dwordx4 v4, s[16:19], s44 offen offset:0 lds
    v_mfma_f32_16x16x32_bf16 v[92:95], a[92:95], v[28:31], v[92:95]
    v_mfma_f32_16x16x32_bf16 v[96:99], a[96:99], v[28:31], v[96:99]
    v_mfma_f32_16x16x32_bf16 v[196:199], a[100:103], v[28:31], v[196:199]
    buffer_load_dwordx4 v5, s[16:19], s44 offen offset:1024 lds
    v_mfma_f32_16x16x32_bf16 v[200:203], a[104:107], v[28:31], v[200:203]
    v_exp_f32 v20, v20
    v_mfma_f32_16x16x32_bf16 v[204:207], a[108:111], v[28:31], v[204:207]
    v_exp_f32 v21, v21
    v_mfma_f32_16x16x32_bf16 v[208:211], a[112:115], v[28:31], v[208:211]
    v_exp_f32 v22, v22
    v_mfma_f32_16x16x32_bf16 v[212:215], a[116:119], v[28:31], v[212:215]
    v_exp_f32 v23, v23
    v_mfma_f32_16x16x32_bf16 a[16:19], a[120:123], v[28:31], a[16:19]
    v_exp_f32 v24, v24
    v_mfma_f32_16x16x32_bf16 a[44:47], a[56:59], v[28:31], a[44:47]
    v_cvt_pk_bf16_f32 v28, v20, v21
    v_cvt_pk_bf16_f32 v29, v22, v23
    v_mfma_f32_16x16x32_bf16 v[20:23], a[60:63], a[240:243], v[56:59]
    v_exp_f32 v25, v25
    v_mfma_f32_16x16x32_bf16 v[20:23], a[64:67], a[244:247], v[20:23]
    v_exp_f32 v26, v26
    v_mfma_f32_16x16x32_bf16 v[20:23], a[68:71], a[248:251], v[20:23]
    v_exp_f32 v27, v27
    v_mfma_f32_16x16x32_bf16 v[20:23], a[72:75], a[252:255], v[20:23]
    s_waitcnt vmcnt(15)
    v_cvt_pk_bf16_f32 v30, v24, v25
    v_cvt_pk_bf16_f32 v31, v26, v27
    v_mfma_f32_16x16x32_bf16 v[24:27], a[76:79], a[240:243], v[56:59]
    ds_read_b128 a[60:63], v8 offset:8192
    ds_read_b128 a[64:67], v9 offset:8192
    v_mfma_f32_16x16x32_bf16 v[24:27], a[80:83], a[244:247], v[24:27]
    buffer_load_dwordx4 v6, s[16:19], s44 offen offset:2048 lds
    v_mfma_f32_16x16x32_bf16 v[24:27], a[84:87], a[248:251], v[24:27]
    ds_read_b128 a[68:71], v8 offset:12288
    ds_read_b128 a[72:75], v9 offset:12288
    v_mfma_f32_16x16x32_bf16 v[24:27], a[88:91], a[252:255], v[24:27]
    v_mfma_f32_16x16x32_bf16 v[100:103], a[92:95], v[28:31], v[100:103]
    ds_read_b128 a[76:79], v8 offset:10240
    ds_read_b128 a[80:83], v9 offset:10240
    v_mfma_f32_16x16x32_bf16 v[104:107], a[96:99], v[28:31], v[104:107]
    buffer_load_dwordx4 v7, s[16:19], s44 offen offset:3072 lds
    v_mfma_f32_16x16x32_bf16 v[216:219], a[100:103], v[28:31], v[216:219]
    ds_read_b128 a[84:87], v8 offset:14336
    ds_read_b128 a[88:91], v9 offset:14336
    v_mfma_f32_16x16x32_bf16 v[220:223], a[104:107], v[28:31], v[220:223]
    s_add_u32 m0, s34, 16384
    v_exp_f32 v20, v20
    v_mfma_f32_16x16x32_bf16 v[224:227], a[108:111], v[28:31], v[224:227]
    s_or_b32 s44, s32, s30
    v_exp_f32 v21, v21
    v_mfma_f32_16x16x32_bf16 v[228:231], a[112:115], v[28:31], v[228:231]
    v_exp_f32 v22, v22
    v_mfma_f32_16x16x32_bf16 v[232:235], a[116:119], v[28:31], v[232:235]
    v_exp_f32 v23, v23
    v_mfma_f32_16x16x32_bf16 a[20:23], a[120:123], v[28:31], a[20:23]
    v_exp_f32 v24, v24
    v_mfma_f32_16x16x32_bf16 a[48:51], a[56:59], v[28:31], a[48:51]
    s_waitcnt lgkmcnt(0)
    v_cvt_pk_bf16_f32 v28, v20, v21
    v_cvt_pk_bf16_f32 v29, v22, v23
    v_mfma_f32_16x16x32_bf16 v[20:23], a[60:63], a[144:147], v[32:35]
    v_exp_f32 v25, v25
    v_mfma_f32_16x16x32_bf16 v[20:23], a[64:67], a[148:151], v[20:23]
    v_exp_f32 v26, v26
    v_mfma_f32_16x16x32_bf16 v[20:23], a[68:71], a[152:155], v[20:23]
    v_exp_f32 v27, v27
    v_mfma_f32_16x16x32_bf16 v[20:23], a[72:75], a[156:159], v[20:23]
    v_cvt_pk_bf16_f32 v30, v24, v25
    v_cvt_pk_bf16_f32 v31, v26, v27
    v_mfma_f32_16x16x32_bf16 v[24:27], a[76:79], a[144:147], v[32:35]
    buffer_load_dwordx4 v4, s[20:23], s44 offen offset:0 lds
    v_mfma_f32_16x16x32_bf16 v[24:27], a[80:83], a[148:151], v[24:27]
    s_waitcnt vmcnt(14)
    v_mfma_f32_16x16x32_bf16 v[24:27], a[84:87], a[152:155], v[24:27]
    ds_read_b64_tr_b16 a[124:125], v13 offset:24576
    ds_read_b64_tr_b16 a[126:127], v13 offset:26624
    v_mfma_f32_16x16x32_bf16 v[24:27], a[88:91], a[156:159], v[24:27]
    buffer_load_dwordx4 v5, s[20:23], s44 offen offset:1024 lds
    v_mfma_f32_16x16x32_bf16 v[108:111], a[92:95], v[28:31], v[108:111]
    ds_read_b64_tr_b16 a[92:93], v10 offset:24576
    ds_read_b64_tr_b16 a[94:95], v10 offset:26624
    v_mfma_f32_16x16x32_bf16 v[112:115], a[96:99], v[28:31], v[112:115]
    ds_read_b64_tr_b16 a[96:97], v11 offset:24576
    ds_read_b64_tr_b16 a[98:99], v11 offset:26624
    v_mfma_f32_16x16x32_bf16 v[236:239], a[100:103], v[28:31], v[236:239]
    ds_read_b64_tr_b16 a[100:101], v12 offset:24576
    ds_read_b64_tr_b16 a[102:103], v12 offset:26624
    v_mfma_f32_16x16x32_bf16 v[240:243], a[104:107], v[28:31], v[240:243]
    v_exp_f32 v20, v20
    v_mfma_f32_16x16x32_bf16 v[244:247], a[108:111], v[28:31], v[244:247]
    v_exp_f32 v21, v21
    v_mfma_f32_16x16x32_bf16 v[248:251], a[112:115], v[28:31], v[248:251]
    v_exp_f32 v22, v22
    v_mfma_f32_16x16x32_bf16 v[252:255], a[116:119], v[28:31], v[252:255]
    v_exp_f32 v23, v23
    v_mfma_f32_16x16x32_bf16 a[24:27], a[120:123], v[28:31], a[24:27]
    s_sub_u32 s35, s35, 1
    v_exp_f32 v24, v24
    v_mfma_f32_16x16x32_bf16 a[52:55], a[56:59], v[28:31], a[52:55]
    s_cmp_lg_u32 s35, 0
    v_cvt_pk_bf16_f32 v28, v20, v21
    v_cvt_pk_bf16_f32 v29, v22, v23
    s_cbranch_scc1 L_loop
    v_mfma_f32_16x16x32_bf16 v[20:23], a[60:63], a[160:163], v[36:39]
    v_exp_f32 v25, v25
    v_mfma_f32_16x16x32_bf16 v[20:23], a[64:67], a[164:167], v[20:23]
    v_exp_f32 v26, v26
    v_mfma_f32_16x16x32_bf16 v[20:23], a[68:71], a[168:171], v[20:23]
    s_waitcnt lgkmcnt(0)
    v_exp_f32 v27, v27
    v_mfma_f32_16x16x32_bf16 v[20:23], a[72:75], a[172:175], v[20:23]
    s_waitcnt vmcnt(10)
    v_cvt_pk_bf16_f32 v30, v24, v25
    v_cvt_pk_bf16_f32 v31, v26, v27
    v_mfma_f32_16x16x32_bf16 v[24:27], a[76:79], a[160:163], v[36:39]
    ds_read_b64_tr_b16 a[108:109], v10 offset:28672
    ds_read_b64_tr_b16 a[110:111], v10 offset:30720
    v_mfma_f32_16x16x32_bf16 v[24:27], a[80:83], a[164:167], v[24:27]
    ds_read_b64_tr_b16 a[112:113], v11 offset:28672
    ds_read_b64_tr_b16 a[114:115], v11 offset:30720
    v_mfma_f32_16x16x32_bf16 v[24:27], a[84:87], a[168:171], v[24:27]
    ds_read_b64_tr_b16 a[116:117], v12 offset:28672
    ds_read_b64_tr_b16 a[118:119], v12 offset:30720
    v_mfma_f32_16x16x32_bf16 v[24:27], a[88:91], a[172:175], v[24:27]
    ds_read_b64_tr_b16 a[120:121], v13 offset:28672
    ds_read_b64_tr_b16 a[122:123], v13 offset:30720
    v_mfma_f32_16x16x32_bf16 v[60:63], a[92:95], v[28:31], v[60:63]
    v_add_u32 v7, s93, v19
    v_subrev_u32 v8, 4096, v19
    v_mfma_f32_16x16x32_bf16 v[64:67], a[96:99], v[28:31], v[64:67]
    v_lshl_add_u32 v4, v0, 4, s90
    v_lshl_add_u32 v5, v0, 4, s91
    v_mfma_f32_16x16x32_bf16 v[116:119], a[100:103], v[28:31], v[116:119]
    v_lshl_add_u32 v6, v0, 4, s92
    v_mfma_f32_16x16x32_bf16 v[120:123], a[124:127], v[28:31], v[120:123]
    s_waitcnt lgkmcnt(4)
    v_exp_f32 v20, v20
    v_mfma_f32_16x16x32_bf16 v[124:127], a[108:111], v[28:31], v[124:127]
    v_exp_f32 v21, v21
    v_mfma_f32_16x16x32_bf16 v[128:131], a[112:115], v[28:31], v[128:131]
    s_waitcnt vmcnt(0) lgkmcnt(0)
    v_exp_f32 v22, v22
    v_mfma_f32_16x16x32_bf16 v[132:135], a[116:119], v[28:31], v[132:135]
    v_exp_f32 v23, v23
    v_mfma_f32_16x16x32_bf16 a[0:3], a[120:123], v[28:31], a[0:3]
    v_exp_f32 v24, v24
    v_mfma_f32_16x16x32_bf16 a[28:31], a[56:59], v[28:31], a[28:31]
    v_cvt_pk_bf16_f32 v28, v20, v21
    v_cvt_pk_bf16_f32 v29, v22, v23
    v_mfma_f32_16x16x32_bf16 v[20:23], a[60:63], a[176:179], v[40:43]
    v_exp_f32 v25, v25
    v_mfma_f32_16x16x32_bf16 v[20:23], a[64:67], a[180:183], v[20:23]
    v_exp_f32 v26, v26
    v_mfma_f32_16x16x32_bf16 v[20:23], a[68:71], a[184:187], v[20:23]
    v_exp_f32 v27, v27
    v_mfma_f32_16x16x32_bf16 v[20:23], a[72:75], a[188:191], v[20:23]
    v_cvt_pk_bf16_f32 v30, v24, v25
    v_cvt_pk_bf16_f32 v31, v26, v27
    v_mfma_f32_16x16x32_bf16 v[24:27], a[76:79], a[176:179], v[40:43]
    v_cvt_pk_bf16_f32 v116, v116, v117
    v_cvt_pk_bf16_f32 v117, v118, v119
    v_cvt_pk_bf16_f32 v118, v120, v121
    v_cvt_pk_bf16_f32 v119, v122, v123
    v_mfma_f32_16x16x32_bf16 v[24:27], a[80:83], a[180:183], v[24:27]
    ds_write_b128 v1, v[116:119] offset:0
    v_mfma_f32_16x16x32_bf16 v[24:27], a[84:87], a[184:187], v[24:27]
    v_cvt_pk_bf16_f32 v124, v124, v125
    v_cvt_pk_bf16_f32 v125, v126, v127
    v_cvt_pk_bf16_f32 v126, v128, v129
    v_cvt_pk_bf16_f32 v127, v130, v131
    v_mfma_f32_16x16x32_bf16 v[24:27], a[88:91], a[188:191], v[24:27]
    v_accvgpr_read_b32 v120, a0
    v_accvgpr_read_b32 v121, a1
    v_accvgpr_read_b32 v122, a2
    v_accvgpr_read_b32 v123, a3
    v_mfma_f32_16x16x32_bf16 v[68:71], a[92:95], v[28:31], v[68:71]
    ds_write_b128 v1, v[124:127] offset:1024
    v_mfma_f32_16x16x32_bf16 v[72:75], a[96:99], v[28:31], v[72:75]
    v_cvt_pk_bf16_f32 v132, v132, v133
    v_cvt_pk_bf16_f32 v133, v134, v135
    v_cvt_pk_bf16_f32 v134, v120, v121
    v_cvt_pk_bf16_f32 v135, v122, v123
    v_mfma_f32_16x16x32_bf16 v[136:139], a[100:103], v[28:31], v[136:139]
    v_exp_f32 v20, v20
    v_mfma_f32_16x16x32_bf16 v[140:143], a[124:127], v[28:31], v[140:143]
    ds_write_b128 v1, v[132:135] offset:2048
    v_mfma_f32_16x16x32_bf16 v[144:147], a[108:111], v[28:31], v[144:147]
    ds_write_b32 v7, a28 offset:0
    v_mfma_f32_16x16x32_bf16 v[148:151], a[112:115], v[28:31], v[148:151]
    v_exp_f32 v21, v21
    v_mfma_f32_16x16x32_bf16 v[152:155], a[116:119], v[28:31], v[152:155]
    v_exp_f32 v22, v22
    v_mfma_f32_16x16x32_bf16 a[4:7], a[120:123], v[28:31], a[4:7]
    v_exp_f32 v23, v23
    v_mfma_f32_16x16x32_bf16 a[32:35], a[56:59], v[28:31], a[32:35]
    v_exp_f32 v24, v24
    v_cvt_pk_bf16_f32 v28, v20, v21
    v_cvt_pk_bf16_f32 v29, v22, v23
    v_mfma_f32_16x16x32_bf16 v[20:23], a[60:63], a[192:195], v[44:47]
    ds_read_b128 v[32:35], v8 offset:0
    ds_read_b128 a[144:147], v4 offset:0
    v_exp_f32 v25, v25
    v_mfma_f32_16x16x32_bf16 v[20:23], a[64:67], a[196:199], v[20:23]
    ds_read_b128 a[148:151], v5 offset:1024
    ds_read_b128 a[152:155], v6 offset:2048
    v_exp_f32 v26, v26
    v_mfma_f32_16x16x32_bf16 v[20:23], a[68:71], a[200:203], v[20:23]
    v_exp_f32 v27, v27
    v_mfma_f32_16x16x32_bf16 v[20:23], a[72:75], a[204:207], v[20:23]
    v_cvt_pk_bf16_f32 v30, v24, v25
    v_cvt_pk_bf16_f32 v31, v26, v27
    v_mfma_f32_16x16x32_bf16 v[24:27], a[76:79], a[192:195], v[44:47]
    v_cvt_pk_bf16_f32 v136, v136, v137
    v_cvt_pk_bf16_f32 v137, v138, v139
    v_cvt_pk_bf16_f32 v138, v140, v141
    v_cvt_pk_bf16_f32 v139, v142, v143
    v_mfma_f32_16x16x32_bf16 v[24:27], a[80:83], a[196:199], v[24:27]
    ds_write_b128 v1, v[136:139] offset:3072
    v_mfma_f32_16x16x32_bf16 v[24:27], a[84:87], a[200:203], v[24:27]
    s_waitcnt lgkmcnt(1)
    v_add_f32 v32, v32, v33
    v_add_f32 v34, v34, v35
    v_add_f32 v32, v32, v34
    v_cmp_gt_f32 vcc, 0, v32
    v_mfma_f32_16x16x32_bf16 v[24:27], a[88:91], a[204:207], v[24:27]
    v_cvt_pk_bf16_f32 v144, v144, v145
    v_cvt_pk_bf16_f32 v145, v146, v147
    s_cbranch_vccnz L_rt0
L_rb0:
    v_mfma_f32_16x16x32_bf16 v[60:63], a[130:133], a[144:147], v[60:63]
    v_cvt_pk_bf16_f32 v146, v148, v149
    v_cvt_pk_bf16_f32 v147, v150, v151
    v_mfma_f32_16x16x32_bf16 v[60:63], a[130:133], a[148:151], v[60:63]
    ds_write_b128 v1, v[144:147] offset:4096
    v_mfma_f32_16x16x32_bf16 v[60:63], a[130:133], a[152:155], v[60:63]
    v_accvgpr_read_b32 v140, a4
    v_accvgpr_read_b32 v141, a5
    v_mfma_f32_16x16x32_bf16 v[64:67], a[128:131], a[144:147], v[64:67]
    v_accvgpr_read_b32 v142, a6
    v_accvgpr_read_b32 v143, a7
    v_mfma_f32_16x16x32_bf16 v[64:67], a[128:131], a[148:151], v[64:67]
    v_cvt_pk_bf16_f32 v152, v152, v153
    v_cvt_pk_bf16_f32 v153, v154, v155
    v_mfma_f32_16x16x32_bf16 v[64:67], a[128:131], a[152:155], v[64:67]
    v_cvt_pk_bf16_f32 v154, v140, v141
    v_cvt_pk_bf16_f32 v155, v142, v143
    v_mfma_f32_16x16x32_bf16 v[76:79], a[92:95], v[28:31], v[76:79]
    ds_write_b128 v1, v[152:155] offset:5120
    v_mfma_f32_16x16x32_bf16 v[80:83], a[96:99], v[28:31], v[80:83]
    ds_write_b32 v7, a32 offset:256
    v_mfma_f32_16x16x32_bf16 v[156:159], a[100:103], v[28:31], v[156:159]
    v_rcp_f32 v34, v32
    v_mfma_f32_16x16x32_bf16 v[160:163], a[124:127], v[28:31], v[160:163]
    v_exp_f32 v20, v20
    v_mfma_f32_16x16x32_bf16 v[164:167], a[108:111], v[28:31], v[164:167]
    v_exp_f32 v21, v21
    v_exp_f32 v22, v22
    v_maximum3_f32 v9, v32, v32, v34
    v_pk_mul_f32 v[60:61], v[60:61], v[34:35] op_sel_hi:[1,0]
    v_pk_mul_f32 v[62:63], v[62:63], v[34:35] op_sel_hi:[1,0]
    v_pk_mul_f32 v[64:65], v[64:65], v[34:35] op_sel_hi:[1,0]
    v_pk_mul_f32 v[66:67], v[66:67], v[34:35] op_sel_hi:[1,0]
    v_mfma_f32_16x16x32_bf16 v[168:171], a[112:115], v[28:31], v[168:171]
    v_cvt_pk_bf16_f32 v60, v60, v61
    v_cvt_pk_bf16_f32 v61, v62, v63
    v_cvt_pk_bf16_f32 v62, v64, v65
    v_cvt_pk_bf16_f32 v63, v66, v67
    v_mfma_f32_16x16x32_bf16 v[172:175], a[116:119], v[28:31], v[172:175]
    v_exp_f32 v23, v23
    v_mfma_f32_16x16x32_bf16 a[8:11], a[120:123], v[28:31], a[8:11]
    s_movk_i32 s98, 0
    v_permlane16_swap_b32 v60, v62
    v_permlane16_swap_b32 v61, v63
    v_mfma_f32_16x16x32_bf16 a[36:39], a[56:59], v[28:31], a[36:39]
    buffer_store_dwordx4 v[60:63], v18, s[24:27], s98 offen sc1
    v_exp_f32 v24, v24
    v_cvt_pk_bf16_f32 v28, v20, v21
    v_cvt_pk_bf16_f32 v29, v22, v23
    v_mfma_f32_16x16x32_bf16 v[20:23], a[60:63], a[208:211], v[48:51]
    ds_read_b128 v[36:39], v8 offset:256
    ds_read_b128 a[160:163], v4 offset:3072
    v_exp_f32 v25, v25
    v_mfma_f32_16x16x32_bf16 v[20:23], a[64:67], a[212:215], v[20:23]
    ds_read_b128 a[164:167], v5 offset:4096
    ds_read_b128 a[168:171], v6 offset:5120
    v_exp_f32 v26, v26
    v_mfma_f32_16x16x32_bf16 v[20:23], a[68:71], a[216:219], v[20:23]
    v_exp_f32 v27, v27
    v_mfma_f32_16x16x32_bf16 v[20:23], a[72:75], a[220:223], v[20:23]
    v_cvt_pk_bf16_f32 v30, v24, v25
    v_cvt_pk_bf16_f32 v31, v26, v27
    v_mfma_f32_16x16x32_bf16 v[24:27], a[76:79], a[208:211], v[48:51]
    v_cvt_pk_bf16_f32 v156, v156, v157
    v_cvt_pk_bf16_f32 v157, v158, v159
    v_cvt_pk_bf16_f32 v158, v160, v161
    v_cvt_pk_bf16_f32 v159, v162, v163
    v_mfma_f32_16x16x32_bf16 v[24:27], a[80:83], a[212:215], v[24:27]
    ds_write_b128 v1, v[156:159] offset:6144
    v_mfma_f32_16x16x32_bf16 v[24:27], a[84:87], a[216:219], v[24:27]
    s_waitcnt lgkmcnt(1)
    v_add_f32 v36, v36, v37
    v_add_f32 v38, v38, v39
    v_add_f32 v36, v36, v38
    v_cmp_gt_f32 vcc, 0, v36
    v_mfma_f32_16x16x32_bf16 v[24:27], a[88:91], a[220:223], v[24:27]
    v_cvt_pk_bf16_f32 v164, v164, v165
    v_cvt_pk_bf16_f32 v165, v166, v167
    s_cbranch_vccnz L_rt1
L_rb1:
    v_mfma_f32_16x16x32_bf16 v[68:71], a[130:133], a[160:163], v[68:71]
    v_cvt_pk_bf16_f32 v166, v168, v169
    v_cvt_pk_bf16_f32 v167, v170, v171
    v_mfma_f32_16x16x32_bf16 v[68:71], a[130:133], a[164:167], v[68:71]
    ds_write_b128 v1, v[164:167] offset:7168
    v_mfma_f32_16x16x32_bf16 v[68:71], a[130:133], a[168:171], v[68:71]
    v_accvgpr_read_b32 v160, a8
    v_accvgpr_read_b32 v161, a9
    v_mfma_f32_16x16x32_bf16 v[72:75], a[128:131], a[160:163], v[72:75]
    v_accvgpr_read_b32 v162, a10
    v_accvgpr_read_b32 v163, a11
    v_mfma_f32_16x16x32_bf16 v[72:75], a[128:131], a[164:167], v[72:75]
    v_cvt_pk_bf16_f32 v172, v172, v173
    v_cvt_pk_bf16_f32 v173, v174, v175
    v_mfma_f32_16x16x32_bf16 v[72:75], a[128:131], a[168:171], v[72:75]
    v_cvt_pk_bf16_f32 v174, v160, v161
    v_cvt_pk_bf16_f32 v175, v162, v163
    v_mfma_f32_16x16x32_bf16 v[84:87], a[92:95], v[28:31], v[84:87]
    ds_write_b128 v1, v[172:175] offset:8192
    v_mfma_f32_16x16x32_bf16 v[88:91], a[96:99], v[28:31], v[88:91]
    ds_write_b32 v7, a36 offset:512
    v_mfma_f32_16x16x32_bf16 v[176:179], a[100:103], v[28:31], v[176:179]
    v_rcp_f32 v38, v36
    v_mfma_f32_16x16x32_bf16 v[180:183], a[124:127], v[28:31], v[180:183]
    v_exp_f32 v20, v20
    v_mfma_f32_16x16x32_bf16 v[184:187], a[108:111], v[28:31], v[184:187]
    v_exp_f32 v21, v21
    v_exp_f32 v22, v22
    v_maximum3_f32 v9, v9, v36, v38
    v_pk_mul_f32 v[68:69], v[68:69], v[38:39] op_sel_hi:[1,0]
    v_pk_mul_f32 v[70:71], v[70:71], v[38:39] op_sel_hi:[1,0]
    v_pk_mul_f32 v[72:73], v[72:73], v[38:39] op_sel_hi:[1,0]
    v_pk_mul_f32 v[74:75], v[74:75], v[38:39] op_sel_hi:[1,0]
    v_mfma_f32_16x16x32_bf16 v[188:191], a[112:115], v[28:31], v[188:191]
    v_cvt_pk_bf16_f32 v68, v68, v69
    v_cvt_pk_bf16_f32 v69, v70, v71
    v_cvt_pk_bf16_f32 v70, v72, v73
    v_cvt_pk_bf16_f32 v71, v74, v75
    v_mfma_f32_16x16x32_bf16 v[192:195], a[116:119], v[28:31], v[192:195]
    v_exp_f32 v23, v23
    v_mfma_f32_16x16x32_bf16 a[12:15], a[120:123], v[28:31], a[12:15]
    s_movk_i32 s98, 4096
    v_permlane16_swap_b32 v68, v70
    v_permlane16_swap_b32 v69, v71
    v_mfma_f32_16x16x32_bf16 a[40:43], a[56:59], v[28:31], a[40:43]
    buffer_store_dwordx4 v[68:71], v18, s[24:27], s98 offen sc1
    v_exp_f32 v24, v24
    v_cvt_pk_bf16_f32 v28, v20, v21
    v_cvt_pk_bf16_f32 v29, v22, v23
    v_mfma_f32_16x16x32_bf16 v[20:23], a[60:63], a[224:227], v[52:55]
    ds_read_b128 v[40:43], v8 offset:512
    ds_read_b128 a[144:147], v4 offset:6144
    v_exp_f32 v25, v25
    v_mfma_f32_16x16x32_bf16 v[20:23], a[64:67], a[228:231], v[20:23]
    ds_read_b128 a[148:151], v5 offset:7168
    ds_read_b128 a[152:155], v6 offset:8192
    v_exp_f32 v26, v26
    v_mfma_f32_16x16x32_bf16 v[20:23], a[68:71], a[232:235], v[20:23]
    v_exp_f32 v27, v27
    v_mfma_f32_16x16x32_bf16 v[20:23], a[72:75], a[236:239], v[20:23]
    v_cvt_pk_bf16_f32 v30, v24, v25
    v_cvt_pk_bf16_f32 v31, v26, v27
    v_mfma_f32_16x16x32_bf16 v[24:27], a[76:79], a[224:227], v[52:55]
    v_cvt_pk_bf16_f32 v176, v176, v177
    v_cvt_pk_bf16_f32 v177, v178, v179
    v_cvt_pk_bf16_f32 v178, v180, v181
    v_cvt_pk_bf16_f32 v179, v182, v183
    v_mfma_f32_16x16x32_bf16 v[24:27], a[80:83], a[228:231], v[24:27]
    ds_write_b128 v1, v[176:179] offset:9216
    v_mfma_f32_16x16x32_bf16 v[24:27], a[84:87], a[232:235], v[24:27]
    s_waitcnt lgkmcnt(1)
    v_add_f32 v40, v40, v41
    v_add_f32 v42, v42, v43
    v_add_f32 v40, v40, v42
    v_cmp_gt_f32 vcc, 0, v40
    v_mfma_f32_16x16x32_bf16 v[24:27], a[88:91], a[236:239], v[24:27]
    v_cvt_pk_bf16_f32 v184, v184, v185
    v_cvt_pk_bf16_f32 v185, v186, v187
    s_cbranch_vccnz L_rt2
L_rb2:
    v_mfma_f32_16x16x32_bf16 v[76:79], a[130:133], a[144:147], v[76:79]
    v_cvt_pk_bf16_f32 v186, v188, v189
    v_cvt_pk_bf16_f32 v187, v190, v191
    v_mfma_f32_16x16x32_bf16 v[76:79], a[130:133], a[148:151], v[76:79]
    ds_write_b128 v1, v[184:187] offset:10240
    v_mfma_f32_16x16x32_bf16 v[76:79], a[130:133], a[152:155], v[76:79]
    v_accvgpr_read_b32 v180, a12
    v_accvgpr_read_b32 v181, a13
    v_mfma_f32_16x16x32_bf16 v[80:83], a[128:131], a[144:147], v[80:83]
    v_accvgpr_read_b32 v182, a14
    v_accvgpr_read_b32 v183, a15
    v_mfma_f32_16x16x32_bf16 v[80:83], a[128:131], a[148:151], v[80:83]
    v_cvt_pk_bf16_f32 v192, v192, v193
    v_cvt_pk_bf16_f32 v193, v194, v195
    v_mfma_f32_16x16x32_bf16 v[80:83], a[128:131], a[152:155], v[80:83]
    v_cvt_pk_bf16_f32 v194, v180, v181
    v_cvt_pk_bf16_f32 v195, v182, v183
    v_mfma_f32_16x16x32_bf16 v[92:95], a[92:95], v[28:31], v[92:95]
    ds_write_b128 v1, v[192:195] offset:11264
    v_mfma_f32_16x16x32_bf16 v[96:99], a[96:99], v[28:31], v[96:99]
    ds_write_b32 v7, a40 offset:768
    v_mfma_f32_16x16x32_bf16 v[196:199], a[100:103], v[28:31], v[196:199]
    v_rcp_f32 v42, v40
    v_mfma_f32_16x16x32_bf16 v[200:203], a[124:127], v[28:31], v[200:203]
    v_exp_f32 v20, v20
    v_mfma_f32_16x16x32_bf16 v[204:207], a[108:111], v[28:31], v[204:207]
    v_exp_f32 v21, v21
    v_exp_f32 v22, v22
    v_maximum3_f32 v9, v9, v40, v42
    v_pk_mul_f32 v[76:77], v[76:77], v[42:43] op_sel_hi:[1,0]
    v_pk_mul_f32 v[78:79], v[78:79], v[42:43] op_sel_hi:[1,0]
    v_pk_mul_f32 v[80:81], v[80:81], v[42:43] op_sel_hi:[1,0]
    v_pk_mul_f32 v[82:83], v[82:83], v[42:43] op_sel_hi:[1,0]
    v_mfma_f32_16x16x32_bf16 v[208:211], a[112:115], v[28:31], v[208:211]
    v_cvt_pk_bf16_f32 v76, v76, v77
    v_cvt_pk_bf16_f32 v77, v78, v79
    v_cvt_pk_bf16_f32 v78, v80, v81
    v_cvt_pk_bf16_f32 v79, v82, v83
    v_mfma_f32_16x16x32_bf16 v[212:215], a[116:119], v[28:31], v[212:215]
    v_exp_f32 v23, v23
    v_mfma_f32_16x16x32_bf16 a[16:19], a[120:123], v[28:31], a[16:19]
    s_movk_i32 s98, 8192
    v_permlane16_swap_b32 v76, v78
    v_permlane16_swap_b32 v77, v79
    v_mfma_f32_16x16x32_bf16 a[44:47], a[56:59], v[28:31], a[44:47]
    buffer_store_dwordx4 v[76:79], v18, s[24:27], s98 offen sc1
    v_exp_f32 v24, v24
    v_cvt_pk_bf16_f32 v28, v20, v21
    v_cvt_pk_bf16_f32 v29, v22, v23
    v_mfma_f32_16x16x32_bf16 v[20:23], a[60:63], a[240:243], v[56:59]
    ds_read_b128 v[44:47], v8 offset:768
    ds_read_b128 a[160:163], v4 offset:9216
    v_exp_f32 v25, v25
    v_mfma_f32_16x16x32_bf16 v[20:23], a[64:67], a[244:247], v[20:23]
    ds_read_b128 a[164:167], v5 offset:10240
    ds_read_b128 a[168:171], v6 offset:11264
    v_exp_f32 v26, v26
    v_mfma_f32_16x16x32_bf16 v[20:23], a[68:71], a[248:251], v[20:23]
    v_exp_f32 v27, v27
    v_mfma_f32_16x16x32_bf16 v[20:23], a[72:75], a[252:255], v[20:23]
    v_cvt_pk_bf16_f32 v30, v24, v25
    v_cvt_pk_bf16_f32 v31, v26, v27
    v_mfma_f32_16x16x32_bf16 v[24:27], a[76:79], a[240:243], v[56:59]
    v_cvt_pk_bf16_f32 v196, v196, v197
    v_cvt_pk_bf16_f32 v197, v198, v199
    v_cvt_pk_bf16_f32 v198, v200, v201
    v_cvt_pk_bf16_f32 v199, v202, v203
    v_mfma_f32_16x16x32_bf16 v[24:27], a[80:83], a[244:247], v[24:27]
    ds_write_b128 v1, v[196:199] offset:12288
    v_mfma_f32_16x16x32_bf16 v[24:27], a[84:87], a[248:251], v[24:27]
    s_waitcnt lgkmcnt(1)
    v_add_f32 v44, v44, v45
    v_add_f32 v46, v46, v47
    v_add_f32 v44, v44, v46
    v_cmp_gt_f32 vcc, 0, v44
    v_mfma_f32_16x16x32_bf16 v[24:27], a[88:91], a[252:255], v[24:27]
    v_cvt_pk_bf16_f32 v204, v204, v205
    v_cvt_pk_bf16_f32 v205, v206, v207
    s_cbranch_vccnz L_rt3
L_rb3:
    v_mfma_f32_16x16x32_bf16 v[84:87], a[130:133], a[160:163], v[84:87]
    v_cvt_pk_bf16_f32 v206, v208, v209
    v_cvt_pk_bf16_f32 v207, v210, v211
    v_mfma_f32_16x16x32_bf16 v[84:87], a[130:133], a[164:167], v[84:87]
    ds_write_b128 v1, v[204:207] offset:13312
    v_mfma_f32_16x16x32_bf16 v[84:87], a[130:133], a[168:171], v[84:87]
    v_accvgpr_read_b32 v200, a16
    v_accvgpr_read_b32 v201, a17
    v_mfma_f32_16x16x32_bf16 v[88:91], a[128:131], a[160:163], v[88:91]
    v_accvgpr_read_b32 v202, a18
    v_accvgpr_read_b32 v203, a19
    v_mfma_f32_16x16x32_bf16 v[88:91], a[128:131], a[164:167], v[88:91]
    v_cvt_pk_bf16_f32 v212, v212, v213
    v_cvt_pk_bf16_f32 v213, v214, v215
    v_mfma_f32_16x16x32_bf16 v[88:91], a[128:131], a[168:171], v[88:91]
    v_cvt_pk_bf16_f32 v214, v200, v201
    v_cvt_pk_bf16_f32 v215, v202, v203
    v_mfma_f32_16x16x32_bf16 v[100:103], a[92:95], v[28:31], v[100:103]
    ds_write_b128 v1, v[212:215] offset:14336
    v_mfma_f32_16x16x32_bf16 v[104:107], a[96:99], v[28:31], v[104:107]
    ds_write_b32 v7, a44 offset:1024
    v_mfma_f32_16x16x32_bf16 v[216:219], a[100:103], v[28:31], v[216:219]
    v_rcp_f32 v46, v44
    v_mfma_f32_16x16x32_bf16 v[220:223], a[124:127], v[28:31], v[220:223]
    v_exp_f32 v20, v20
    v_mfma_f32_16x16x32_bf16 v[224:227], a[108:111], v[28:31], v[224:227]
    v_exp_f32 v21, v21
    v_exp_f32 v22, v22
    v_maximum3_f32 v9, v9, v44, v46
    v_pk_mul_f32 v[84:85], v[84:85], v[46:47] op_sel_hi:[1,0]
    v_pk_mul_f32 v[86:87], v[86:87], v[46:47] op_sel_hi:[1,0]
    v_pk_mul_f32 v[88:89], v[88:89], v[46:47] op_sel_hi:[1,0]
    v_pk_mul_f32 v[90:91], v[90:91], v[46:47] op_sel_hi:[1,0]
    v_mfma_f32_16x16x32_bf16 v[228:231], a[112:115], v[28:31], v[228:231]
    v_cvt_pk_bf16_f32 v84, v84, v85
    v_cvt_pk_bf16_f32 v85, v86, v87
    v_cvt_pk_bf16_f32 v86, v88, v89
    v_cvt_pk_bf16_f32 v87, v90, v91
    v_mfma_f32_16x16x32_bf16 v[232:235], a[116:119], v[28:31], v[232:235]
    v_exp_f32 v23, v23
    v_mfma_f32_16x16x32_bf16 a[20:23], a[120:123], v[28:31], a[20:23]
    s_movk_i32 s98, 12288
    v_permlane16_swap_b32 v84, v86
    v_permlane16_swap_b32 v85, v87
    v_mfma_f32_16x16x32_bf16 a[48:51], a[56:59], v[28:31], a[48:51]
    buffer_store_dwordx4 v[84:87], v18, s[24:27], s98 offen sc1
    v_exp_f32 v24, v24
    v_cvt_pk_bf16_f32 v28, v20, v21
    v_cvt_pk_bf16_f32 v29, v22, v23
    ds_read_b128 v[48:51], v8 offset:1024
    ds_read_b128 a[144:147], v4 offset:12288
    ds_read_b128 a[148:151], v5 offset:13312
    ds_read_b128 a[152:155], v6 offset:14336
    v_exp_f32 v25, v25
    v_exp_f32 v26, v26
    v_exp_f32 v27, v27
    v_cvt_pk_bf16_f32 v216, v216, v217
    v_cvt_pk_bf16_f32 v30, v24, v25
    v_cvt_pk_bf16_f32 v31, v26, v27
    v_cvt_pk_bf16_f32 v217, v218, v219
    v_cvt_pk_bf16_f32 v218, v220, v221
    v_cvt_pk_bf16_f32 v219, v222, v223
    v_mfma_f32_16x16x32_bf16 v[236:239], a[100:103], v[28:31], v[236:239]
    ds_write_b128 v1, v[216:219] offset:15360
    v_mfma_f32_16x16x32_bf16 v[240:243], a[124:127], v[28:31], v[240:243]
    v_cvt_pk_bf16_f32 v224, v224, v225
    v_cvt_pk_bf16_f32 v225, v226, v227
    v_cvt_pk_bf16_f32 v226, v228, v229
    v_cvt_pk_bf16_f32 v227, v230, v231
    v_mfma_f32_16x16x32_bf16 v[244:247], a[108:111], v[28:31], v[244:247]
    v_accvgpr_read_b32 v220, a20
    v_accvgpr_read_b32 v221, a21
    v_accvgpr_read_b32 v222, a22
    v_accvgpr_read_b32 v223, a23
    v_mfma_f32_16x16x32_bf16 v[248:251], a[112:115], v[28:31], v[248:251]
    ds_write_b128 v1, v[224:227] offset:16384
    v_mfma_f32_16x16x32_bf16 v[252:255], a[116:119], v[28:31], v[252:255]
    v_cvt_pk_bf16_f32 v232, v232, v233
    v_cvt_pk_bf16_f32 v233, v234, v235
    v_cvt_pk_bf16_f32 v234, v220, v221
    v_cvt_pk_bf16_f32 v235, v222, v223
    v_mfma_f32_16x16x32_bf16 a[24:27], a[120:123], v[28:31], a[24:27]
    s_waitcnt lgkmcnt(2)
    v_add_f32 v48, v48, v49
    v_add_f32 v50, v50, v51
    v_add_f32 v48, v48, v50
    v_cmp_gt_f32 vcc, 0, v48
    v_mfma_f32_16x16x32_bf16 a[52:55], a[56:59], v[28:31], a[52:55]
    ds_write_b128 v1, v[232:235] offset:17408
    ds_write_b32 v7, a48 offset:1280
    v_mfma_f32_16x16x32_bf16 v[108:111], a[92:95], v[28:31], v[108:111]
    s_cbranch_vccnz L_rt4
L_rb4:
    v_cvt_pk_bf16_f32 v236, v236, v237
    v_cvt_pk_bf16_f32 v237, v238, v239
    v_cvt_pk_bf16_f32 v238, v240, v241
    v_cvt_pk_bf16_f32 v239, v242, v243
    v_mfma_f32_16x16x32_bf16 v[112:115], a[96:99], v[28:31], v[112:115]
    v_rcp_f32 v50, v48
    v_mfma_f32_16x16x32_bf16 v[92:95], a[130:133], a[144:147], v[92:95]
    ds_write_b128 v1, v[236:239] offset:18432
    v_mfma_f32_16x16x32_bf16 v[92:95], a[130:133], a[148:151], v[92:95]
    v_cvt_pk_bf16_f32 v244, v244, v245
    v_cvt_pk_bf16_f32 v245, v246, v247
    v_cvt_pk_bf16_f32 v246, v248, v249
    v_cvt_pk_bf16_f32 v247, v250, v251
    v_maximum3_f32 v9, v9, v48, v50
    v_mfma_f32_16x16x32_bf16 v[92:95], a[130:133], a[152:155], v[92:95]
    v_accvgpr_read_b32 v240, a24
    v_accvgpr_read_b32 v241, a25
    v_accvgpr_read_b32 v242, a26
    v_accvgpr_read_b32 v243, a27
    v_mfma_f32_16x16x32_bf16 v[96:99], a[128:131], a[144:147], v[96:99]
    ds_write_b128 v1, v[244:247] offset:19456
    v_mfma_f32_16x16x32_bf16 v[96:99], a[128:131], a[148:151], v[96:99]
    ds_read_b128 v[52:55], v8 offset:1280
    ds_read_b128 a[160:163], v4 offset:15360
    ds_read_b128 a[164:167], v5 offset:16384
    ds_read_b128 a[168:171], v6 offset:17408
    v_cvt_pk_bf16_f32 v252, v252, v253
    v_cvt_pk_bf16_f32 v253, v254, v255
    v_cvt_pk_bf16_f32 v254, v240, v241
    v_cvt_pk_bf16_f32 v255, v242, v243
    v_mfma_f32_16x16x32_bf16 v[96:99], a[128:131], a[152:155], v[96:99]
    ds_write_b128 v1, v[252:255] offset:20480
    ds_write_b32 v7, a52 offset:1536
    s_movk_i32 s98, 16384
    s_mov_b32 s99, 0x53800000
    s_waitcnt lgkmcnt(2)
    v_add_f32 v52, v52, v53
    v_add_f32 v54, v54, v55
    v_add_f32 v52, v52, v54
    v_cmp_gt_f32 vcc, 0, v52
    v_pk_mul_f32 v[92:93], v[92:93], v[50:51] op_sel_hi:[1,0]
    v_pk_mul_f32 v[94:95], v[94:95], v[50:51] op_sel_hi:[1,0]
    v_pk_mul_f32 v[96:97], v[96:97], v[50:51] op_sel_hi:[1,0]
    v_pk_mul_f32 v[98:99], v[98:99], v[50:51] op_sel_hi:[1,0]
    v_cvt_pk_bf16_f32 v92, v92, v93
    v_cvt_pk_bf16_f32 v93, v94, v95
    v_cvt_pk_bf16_f32 v94, v96, v97
    v_cvt_pk_bf16_f32 v95, v98, v99
    s_cbranch_vccnz L_rt5
L_rb5:
    ds_read_b128 v[56:59], v8 offset:1536
    ds_read_b128 a[144:147], v4 offset:18432
    ds_read_b128 a[148:151], v5 offset:19456
    ds_read_b128 a[152:155], v6 offset:20480
    v_mfma_f32_16x16x32_bf16 v[100:103], a[130:133], a[160:163], v[100:103]
    v_permlane16_swap_b32 v92, v94
    v_permlane16_swap_b32 v93, v95
    v_mfma_f32_16x16x32_bf16 v[100:103], a[130:133], a[164:167], v[100:103]
    buffer_store_dwordx4 v[92:95], v18, s[24:27], s98 offen sc1
    v_mfma_f32_16x16x32_bf16 v[100:103], a[130:133], a[168:171], v[100:103]
    v_rcp_f32 v54, v52
    v_mfma_f32_16x16x32_bf16 v[104:107], a[128:131], a[160:163], v[104:107]
    v_mfma_f32_16x16x32_bf16 v[104:107], a[128:131], a[164:167], v[104:107]
    s_waitcnt lgkmcnt(0)
    v_add_f32 v56, v56, v57
    v_add_f32 v58, v58, v59
    v_add_f32 v56, v56, v58
    v_cmp_gt_f32 vcc, 0, v56
    v_mfma_f32_16x16x32_bf16 v[104:107], a[128:131], a[168:171], v[104:107]
    v_maximum3_f32 v9, v9, v52, v54
    v_mul_f32 v100, v100, v54
    s_cbranch_vccnz L_rt6
L_rb6:
    v_mfma_f32_16x16x32_bf16 v[108:111], a[130:133], a[144:147], v[108:111]
    s_movk_i32 s98, 20480
    v_rcp_f32 v58, v56
    v_mfma_f32_16x16x32_bf16 v[108:111], a[130:133], a[148:151], v[108:111]
    v_mul_f32 v101, v101, v54
    v_mul_f32 v102, v102, v54
    v_mul_f32 v103, v103, v54
    v_mfma_f32_16x16x32_bf16 v[108:111], a[130:133], a[152:155], v[108:111]
    v_maximum3_f32 v9, v9, v56, v58
    s_cmp_lg_u32 s33, 0
    v_mfma_f32_16x16x32_bf16 v[112:115], a[128:131], a[144:147], v[112:115]
    v_mul_f32 v104, v104, v54
    v_mul_f32 v105, v105, v54
    v_mul_f32 v106, v106, v54
    v_mul_f32 v107, v107, v54
    v_mfma_f32_16x16x32_bf16 v[112:115], a[128:131], a[148:151], v[112:115]
    v_cvt_pk_bf16_f32 v100, v100, v101
    v_cvt_pk_bf16_f32 v101, v102, v103
    v_cvt_pk_bf16_f32 v102, v104, v105
    v_cvt_pk_bf16_f32 v103, v106, v107
    v_mfma_f32_16x16x32_bf16 v[112:115], a[128:131], a[152:155], v[112:115]
    v_cmp_ngt_f32 vcc, s99, v9
    s_nop 0
    v_permlane16_swap_b32 v100, v102
    v_permlane16_swap_b32 v101, v103
    s_nop 0
    buffer_store_dwordx4 v[100:103], v18, s[24:27], s98 offen sc1
    s_movk_i32 s98, 24576
    s_nop 0
    v_pk_mul_f32 v[108:109], v[108:109], v[58:59] op_sel_hi:[1,0]
    v_pk_mul_f32 v[110:111], v[110:111], v[58:59] op_sel_hi:[1,0]
    v_pk_mul_f32 v[112:113], v[112:113], v[58:59] op_sel_hi:[1,0]
    v_pk_mul_f32 v[114:115], v[114:115], v[58:59] op_sel_hi:[1,0]
    v_cvt_pk_bf16_f32 v108, v108, v109
    v_cvt_pk_bf16_f32 v109, v110, v111
    v_cvt_pk_bf16_f32 v110, v112, v113
    v_cvt_pk_bf16_f32 v111, v114, v115
    s_nop 1
    v_permlane16_swap_b32 v108, v110
    v_permlane16_swap_b32 v109, v111
    s_nop 0
    buffer_store_dwordx4 v[108:111], v18, s[24:27], s98 offen sc1
    s_cbranch_scc1 L_ok
    s_cbranch_vccnz L_fallback
L_ok:
L_end:
    s_endpgm
L_rt0:
    ds_read_b128 v[32:35], v8 offset:0
    ds_read_b128 a[144:147], v4 offset:0
    ds_read_b128 a[148:151], v5 offset:1024
    ds_read_b128 a[152:155], v6 offset:2048
    s_waitcnt lgkmcnt(0)
    v_add_f32 v32, v32, v33
    v_add_f32 v34, v34, v35
    v_add_f32 v32, v32, v34
    v_cmp_gt_f32 vcc, 0, v32
    s_nop 1
    s_cbranch_vccnz L_rt0
    s_branch L_rb0
L_rt1:
    ds_read_b128 v[36:39], v8 offset:256
    ds_read_b128 a[160:163], v4 offset:3072
    ds_read_b128 a[164:167], v5 offset:4096
    ds_read_b128 a[168:171], v6 offset:5120
    s_waitcnt lgkmcnt(0)
    v_add_f32 v36, v36, v37
    v_add_f32 v38, v38, v39
    v_add_f32 v36, v36, v38
    v_cmp_gt_f32 vcc, 0, v36
    s_nop 1
    s_cbranch_vccnz L_rt1
    s_branch L_rb1
L_rt2:
    ds_read_b128 v[40:43], v8 offset:512
    ds_read_b128 a[144:147], v4 offset:6144
    ds_read_b128 a[148:151], v5 offset:7168
    ds_read_b128 a[152:155], v6 offset:8192
    s_waitcnt lgkmcnt(0)
    v_add_f32 v40, v40, v41
    v_add_f32 v42, v42, v43
    v_add_f32 v40, v40, v42
    v_cmp_gt_f32 vcc, 0, v40
    s_nop 1
    s_cbranch_vccnz L_rt2
    s_branch L_rb2
L_rt3:
    ds_read_b128 v[44:47], v8 offset:768
    ds_read_b128 a[160:163], v4 offset:9216
    ds_read_b128 a[164:167], v5 offset:10240
    ds_read_b128 a[168:171], v6 offset:11264
    s_waitcnt lgkmcnt(0)
    v_add_f32 v44, v44, v45
    v_add_f32 v46, v46, v47
    v_add_f32 v44, v44, v46
    v_cmp_gt_f32 vcc, 0, v44
    s_nop 1
    s_cbranch_vccnz L_rt3
    s_branch L_rb3
L_rt4:
    ds_read_b128 v[48:51], v8 offset:1024
    ds_read_b128 a[144:147], v4 offset:12288
    ds_read_b128 a[148:151], v5 offset:13312
    ds_read_b128 a[152:155], v6 offset:14336
    s_waitcnt lgkmcnt(0)
    v_add_f32 v48, v48, v49
    v_add_f32 v50, v50, v51
    v_add_f32 v48, v48, v50
    v_cmp_gt_f32 vcc, 0, v48
    s_nop 1
    s_cbranch_vccnz L_rt4
    s_branch L_rb4
L_rt5:
    ds_read_b128 v[52:55], v8 offset:1280
    ds_read_b128 a[160:163], v4 offset:15360
    ds_read_b128 a[164:167], v5 offset:16384
    ds_read_b128 a[168:171], v6 offset:17408
    s_waitcnt lgkmcnt(0)
    v_add_f32 v52, v52, v53
    v_add_f32 v54, v54, v55
    v_add_f32 v52, v52, v54
    v_cmp_gt_f32 vcc, 0, v52
    s_nop 1
    s_cbranch_vccnz L_rt5
    s_branch L_rb5
L_rt6:
    ds_read_b128 v[56:59], v8 offset:1536
    ds_read_b128 a[144:147], v4 offset:18432
    ds_read_b128 a[148:151], v5 offset:19456
    ds_read_b128 a[152:155], v6 offset:20480
    s_waitcnt lgkmcnt(0)
    v_add_f32 v56, v56, v57
    v_add_f32 v58, v58, v59
    v_add_f32 v56, v56, v58
    v_cmp_gt_f32 vcc, 0, v56
    s_nop 1
    s_cbranch_vccnz L_rt6
    s_branch L_rb6
L_fallback:
    s_waitcnt vmcnt(0) lgkmcnt(0)
    s_barrier
    s_mov_b32 s33, 1
    s_branch L_start
L_pass1:
    s_waitcnt lgkmcnt(0)
    s_barrier
    ds_read_b128 a[144:147], v14 offset:0
    ds_read_b128 a[148:151], v14 offset:1024
    ds_read_b128 a[152:155], v14 offset:4096
    ds_read_b128 a[156:159], v14 offset:5120
    s_waitcnt lgkmcnt(0)
    ds_read_b128 a[160:163], v14 offset:40960
    ds_read_b128 a[164:167], v14 offset:41984
    ds_read_b128 a[168:171], v14 offset:45056
    ds_read_b128 a[172:175], v14 offset:46080
    s_waitcnt lgkmcnt(0)
    ds_read_b128 a[176:179], v15 offset:0
    ds_read_b128 a[180:183], v15 offset:1024
    ds_read_b128 a[184:187], v15 offset:4096
    ds_read_b128 a[188:191], v15 offset:5120
    s_waitcnt lgkmcnt(0)
    ds_read_b128 a[192:195], v15 offset:40960
    ds_read_b128 a[196:199], v15 offset:41984
    ds_read_b128 a[200:203], v15 offset:45056
    ds_read_b128 a[204:207], v15 offset:46080
    s_waitcnt lgkmcnt(0)
    ds_read_b128 a[208:211], v14 offset:2048
    ds_read_b128 a[212:215], v14 offset:3072
    ds_read_b128 a[216:219], v14 offset:6144
    ds_read_b128 a[220:223], v14 offset:7168
    s_waitcnt lgkmcnt(0)
    ds_read_b128 a[224:227], v14 offset:43008
    ds_read_b128 a[228:231], v14 offset:44032
    ds_read_b128 a[232:235], v14 offset:47104
    ds_read_b128 a[236:239], v14 offset:48128
    s_waitcnt lgkmcnt(0)
    ds_read_b128 a[240:243], v15 offset:2048
    ds_read_b128 a[244:247], v15 offset:3072
    ds_read_b128 a[248:251], v15 offset:6144
    ds_read_b128 a[252:255], v15 offset:7168
    s_waitcnt lgkmcnt(0)
    s_waitcnt vmcnt(0)
    s_barrier
    s_mov_b32 s42, 0
    v_mov_b32 v60, 0xff800000
    v_mov_b32 v61, 0xff800000
    v_mov_b32 v62, 0xff800000
    v_mov_b32 v63, 0xff800000
    v_mov_b32 v64, 0xff800000
    v_mov_b32 v65, 0xff800000
    v_mov_b32 v66, 0xff800000
L_fb1:
    s_add_u32 m0, s34, 0
    s_add_u32 s44, s42, 128
    buffer_load_dwordx4 v4, s[16:19], s42 offen offset:0 lds
    buffer_load_dwordx4 v5, s[16:19], s42 offen offset:1024 lds
    buffer_load_dwordx4 v6, s[16:19], s42 offen offset:2048 lds
    buffer_load_dwordx4 v7, s[16:19], s42 offen offset:3072 lds
    s_add_u32 m0, s34, 4096
    s_nop 0
    buffer_load_dwordx4 v4, s[16:19], s44 offen offset:0 lds
    buffer_load_dwordx4 v5, s[16:19], s44 offen offset:1024 lds
    buffer_load_dwordx4 v6, s[16:19], s44 offen offset:2048 lds
    buffer_load_dwordx4 v7, s[16:19], s44 offen offset:3072 lds
    s_waitcnt vmcnt(0)
    ds_read_b128 a[60:63], v8 offset:0
    ds_read_b128 a[64:67], v9 offset:0
    ds_read_b128 a[68:71], v8 offset:4096
    ds_read_b128 a[72:75], v9 offset:4096
    ds_read_b128 a[76:79], v8 offset:2048
    ds_read_b128 a[80:83], v9 offset:2048
    ds_read_b128 a[84:87], v8 offset:6144
    ds_read_b128 a[88:91], v9 offset:6144
    s_waitcnt lgkmcnt(0)
    v_mfma_f32_16x16x32_bf16 v[20:23], a[60:63], a[144:147], 0
    v_mfma_f32_16x16x32_bf16 v[20:23], a[64:67], a[148:151], v[20:23]
    v_mfma_f32_16x16x32_bf16 v[20:23], a[68:71], a[152:155], v[20:23]
    v_mfma_f32_16x16x32_bf16 v[20:23], a[72:75], a[156:159], v[20:23]
    v_mfma_f32_16x16x32_bf16 v[24:27], a[76:79], a[144:147], 0
    v_mfma_f32_16x16x32_bf16 v[24:27], a[80:83], a[148:151], v[24:27]
    v_mfma_f32_16x16x32_bf16 v[24:27], a[84:87], a[152:155], v[24:27]
    v_mfma_f32_16x16x32_bf16 v[24:27], a[88:91], a[156:159], v[24:27]
    s_nop 7
    v_max3_f32 v60, v60, v20, v21
    v_max3_f32 v60, v60, v22, v23
    v_max3_f32 v60, v60, v24, v25
    v_max3_f32 v60, v60, v26, v27
    v_mfma_f32_16x16x32_bf16 v[20:23], a[60:63], a[160:163], 0
    v_mfma_f32_16x16x32_bf16 v[20:23], a[64:67], a[164:167], v[20:23]
    v_mfma_f32_16x16x32_bf16 v[20:23], a[68:71], a[168:171], v[20:23]
    v_mfma_f32_16x16x32_bf16 v[20:23], a[72:75], a[172:175], v[20:23]
    v_mfma_f32_16x16x32_bf16 v[24:27], a[76:79], a[160:163], 0
    v_mfma_f32_16x16x32_bf16 v[24:27], a[80:83], a[164:167], v[24:27]
    v_mfma_f32_16x16x32_bf16 v[24:27], a[84:87], a[168:171], v[24:27]
    v_mfma_f32_16x16x32_bf16 v[24:27], a[88:91], a[172:175], v[24:27]
    s_nop 7
    v_max3_f32 v61, v61, v20, v21
    v_max3_f32 v61, v61, v22, v23
    v_max3_f32 v61, v61, v24, v25
    v_max3_f32 v61, v61, v26, v27
    v_mfma_f32_16x16x32_bf16 v[20:23], a[60:63], a[176:179], 0
    v_mfma_f32_16x16x32_bf16 v[20:23], a[64:67], a[180:183], v[20:23]
    v_mfma_f32_16x16x32_bf16 v[20:23], a[68:71], a[184:187], v[20:23]
    v_mfma_f32_16x16x32_bf16 v[20:23], a[72:75], a[188:191], v[20:23]
    v_mfma_f32_16x16x32_bf16 v[24:27], a[76:79], a[176:179], 0
    v_mfma_f32_16x16x32_bf16 v[24:27], a[80:83], a[180:183], v[24:27]
    v_mfma_f32_16x16x32_bf16 v[24:27], a[84:87], a[184:187], v[24:27]
    v_mfma_f32_16x16x32_bf16 v[24:27], a[88:91], a[188:191], v[24:27]
    s_nop 7
    v_max3_f32 v62, v62, v20, v21
    v_max3_f32 v62, v62, v22, v23
    v_max3_f32 v62, v62, v24, v25
    v_max3_f32 v62, v62, v26, v27
    v_mfma_f32_16x16x32_bf16 v[20:23], a[60:63], a[192:195], 0
    v_mfma_f32_16x16x32_bf16 v[20:23], a[64:67], a[196:199], v[20:23]
    v_mfma_f32_16x16x32_bf16 v[20:23], a[68:71], a[200:203], v[20:23]
    v_mfma_f32_16x16x32_bf16 v[20:23], a[72:75], a[204:207], v[20:23]
    v_mfma_f32_16x16x32_bf16 v[24:27], a[76:79], a[192:195], 0
    v_mfma_f32_16x16x32_bf16 v[24:27], a[80:83], a[196:199], v[24:27]
    v_mfma_f32_16x16x32_bf16 v[24:27], a[84:87], a[200:203], v[24:27]
    v_mfma_f32_16x16x32_bf16 v[24:27], a[88:91], a[204:207], v[24:27]
    s_nop 7
    v_max3_f32 v63, v63, v20, v21
    v_max3_f32 v63, v63, v22, v23
    v_max3_f32 v63, v63, v24, v25
    v_max3_f32 v63, v63, v26, v27
    v_mfma_f32_16x16x32_bf16 v[20:23], a[60:63], a[208:211], 0
    v_mfma_f32_16x16x32_bf16 v[20:23], a[64:67], a[212:215], v[20:23]
    v_mfma_f32_16x16x32_bf16 v[20:23], a[68:71], a[216:219], v[20:23]
    v_mfma_f32_16x16x32_bf16 v[20:23], a[72:75], a[220:223], v[20:23]
    v_mfma_f32_16x16x32_bf16 v[24:27], a[76:79], a[208:211], 0
    v_mfma_f32_16x16x32_bf16 v[24:27], a[80:83], a[212:215], v[24:27]
    v_mfma_f32_16x16x32_bf16 v[24:27], a[84:87], a[216:219], v[24:27]
    v_mfma_f32_16x16x32_bf16 v[24:27], a[88:91], a[220:223], v[24:27]
    s_nop 7
    v_max3_f32 v64, v64, v20, v21
    v_max3_f32 v64, v64, v22, v23
    v_max3_f32 v64, v64, v24, v25
    v_max3_f32 v64, v64, v26, v27
    v_mfma_f32_16x16x32_bf16 v[20:23], a[60:63], a[224:227], 0
    v_mfma_f32_16x16x32_bf16 v[20:23], a[64:67], a[228:231], v[20:23]
    v_mfma_f32_16x16x32_bf16 v[20:23], a[68:71], a[232:235], v[20:23]
    v_mfma_f32_16x16x32_bf16 v[20:23], a[72:75], a[236:239], v[20:23]
    v_mfma_f32_16x16x32_bf16 v[24:27], a[76:79], a[224:227], 0
    v_mfma_f32_16x16x32_bf16 v[24:27], a[80:83], a[228:231], v[24:27]
    v_mfma_f32_16x16x32_bf16 v[24:27], a[84:87], a[232:235], v[24:27]
    v_mfma_f32_16x16x32_bf16 v[24:27], a[88:91], a[236:239], v[24:27]
    s_nop 7
    v_max3_f32 v65, v65, v20, v21
    v_max3_f32 v65, v65, v22, v23
    v_max3_f32 v65, v65, v24, v25
    v_max3_f32 v65, v65, v26, v27
    v_mfma_f32_16x16x32_bf16 v[20:23], a[60:63], a[240:243], 0
    v_mfma_f32_16x16x32_bf16 v[20:23], a[64:67], a[244:247], v[20:23]
    v_mfma_f32_16x16x32_bf16 v[20:23], a[68:71], a[248:251], v[20:23]
    v_mfma_f32_16x16x32_bf16 v[20:23], a[72:75], a[252:255], v[20:23]
    v_mfma_f32_16x16x32_bf16 v[24:27], a[76:79], a[240:243], 0
    v_mfma_f32_16x16x32_bf16 v[24:27], a[80:83], a[244:247], v[24:27]
    v_mfma_f32_16x16x32_bf16 v[24:27], a[84:87], a[248:251], v[24:27]
    v_mfma_f32_16x16x32_bf16 v[24:27], a[88:91], a[252:255], v[24:27]
    s_nop 7
    v_max3_f32 v66, v66, v20, v21
    v_max3_f32 v66, v66, v22, v23
    v_max3_f32 v66, v66, v24, v25
    v_max3_f32 v66, v66, v26, v27
    s_add_u32 s42, s42, 0x2000
    s_cmp_lt_u32 s42, 0x10000
    s_cbranch_scc1 L_fb1
    v_mov_b32 v68, v60
    v_mov_b32 v69, v61
    v_mov_b32 v70, v62
    v_mov_b32 v71, v63
    v_mov_b32 v72, v64
    v_mov_b32 v73, v65
    v_mov_b32 v74, v66
    s_nop 1
    v_permlane16_swap_b32 v60, v68
    v_permlane16_swap_b32 v61, v69
    v_permlane16_swap_b32 v62, v70
    v_permlane16_swap_b32 v63, v71
    v_permlane16_swap_b32 v64, v72
    v_permlane16_swap_b32 v65, v73
    v_permlane16_swap_b32 v66, v74
    s_nop 1
    v_max_f32 v60, v60, v68
    v_max_f32 v61, v61, v69
    v_max_f32 v62, v62, v70
    v_max_f32 v63, v63, v71
    v_max_f32 v64, v64, v72
    v_max_f32 v65, v65, v73
    v_max_f32 v66, v66, v74
    v_mov_b32 v68, v60
    v_mov_b32 v69, v61
    v_mov_b32 v70, v62
    v_mov_b32 v71, v63
    v_mov_b32 v72, v64
    v_mov_b32 v73, v65
    v_mov_b32 v74, v66
    s_nop 1
    v_permlane32_swap_b32 v60, v68
    v_permlane32_swap_b32 v61, v69
    v_permlane32_swap_b32 v62, v70
    v_permlane32_swap_b32 v63, v71
    v_permlane32_swap_b32 v64, v72
    v_permlane32_swap_b32 v65, v73
    v_permlane32_swap_b32 v66, v74
    s_nop 1
    v_max_f32 v60, v60, v68
    v_max_f32 v61, v61, v69
    v_max_f32 v62, v62, v70
    v_max_f32 v63, v63, v71
    v_max_f32 v64, v64, v72
    v_max_f32 v65, v65, v73
    v_max_f32 v66, v66, v74
    v_add_u32 v28, s93, v19
    ds_write_b32 v28, v60 offset:0
    ds_write_b32 v28, v61 offset:256
    ds_write_b32 v28, v62 offset:512
    ds_write_b32 v28, v63 offset:768
    ds_write_b32 v28, v64 offset:1024
    ds_write_b32 v28, v65 offset:1280
    ds_write_b32 v28, v66 offset:1536
    s_waitcnt lgkmcnt(0)
    s_barrier
    s_lshl_b32 s42, s3, 8
    s_sub_u32 s42, s42, 4096
    v_add_u32 v28, s42, v19
    ds_read_b128 v[20:23], v28 offset:0
    ds_read_b128 v[24:27], v28 offset:1024
    s_waitcnt lgkmcnt(0)
    v_max3_f32 v2, v20, v21, v22
    v_max_f32 v2, v2, v23
    v_max3_f32 v3, v24, v25, v26
    v_max_f32 v3, v3, v27
    s_mov_b32 s33, 2
    s_mov_b64 s[88:89], -1
    s_barrier
    s_branch L_start
.section .rodata,"a"
.p2align 6
.amdhsa_kernel standalone__gqa_softmax__near_ridge_kernel
  .amdhsa_next_free_vgpr 512
  .amdhsa_next_free_sgpr 102
  .amdhsa_accum_offset 256
  .amdhsa_group_segment_fixed_size 0
  .amdhsa_kernarg_size 48
  .amdhsa_user_sgpr_count 2
  .amdhsa_user_sgpr_kernarg_segment_ptr 1
  .amdhsa_system_sgpr_workgroup_id_x 1
.end_amdhsa_kernel
```
